```python
import torch

def _softmax(x, axis=-1):
    return torch.softmax(x, dim=axis)
def _gelu(x):
    return torch.nn.functional.gelu(x, approximate="tanh")
def _silu(x):
    return torch.nn.functional.silu(x)
def _sigmoid(x):
    return torch.sigmoid(x)
def _layernorm(x, axis=-1, eps=1e-5):
    m = x.mean(dim=axis, keepdim=True)
    v = x.var(dim=axis, keepdim=True, unbiased=False)
    return (x - m) / torch.sqrt(v + eps)
def _scatter_add(tgt, idx, src, axis=0):
    return tgt.clone().index_add_(axis, idx, src)
def _segment_sum(src, seg, n):
    out = torch.zeros((n,) + src.shape[1:], dtype=src.dtype)
    return out.index_add_(0, seg, src)
def _pad(x, pw):
    flat = tuple(v for pair in reversed(pw) for v in pair)
    return torch.nn.functional.pad(x, flat)

kernel_name = 'recurrent_scan__gqa_block_cached__mixer_token_mlp__decode'

def setup_inputs():

    _w = (lambda a: (lambda t: t.to(torch.bfloat16) if t.is_floating_point() else t)(torch.as_tensor(a)))
    def _A_setup():
        B, Sq, D = 1, 1, 512
        Hq, Hkv, Sk, Dh = 32, 8, 65536, 128
        assert Hq % Hkv == 0, (Hq, Hkv)
        return {
            "x": _w((lambda *s: torch.randn(*s, dtype=torch.bfloat16) * 0.4)(B, Sq, D)),
            "k_cache": _w((lambda *s: torch.randn(*s, dtype=torch.bfloat16) * 3.2)(B, Hkv, Sk, Dh)),
            "v_cache": _w((lambda *s: torch.randn(*s, dtype=torch.bfloat16) * 1.6)(B, Hkv, Sk, Dh)),
            "wq": _w((lambda *s: torch.randn(*s, dtype=torch.bfloat16) * 3.2)(D, Hq * Dh) * (D ** -0.5)),
            "wo": _w((lambda *s: torch.randn(*s, dtype=torch.bfloat16) * 1.6)(Hq * Dh, D) * ((Hq * Dh) ** -0.5)),
        }
    _A_in = _A_setup()

    def _B_setup():
        B, S, D, F = 1, 1, 512, 1792
        return {
            "x": _w((lambda *s: torch.randn(*s, dtype=torch.bfloat16) * 0.4)(B, S, D)),
            "w1": _w((lambda *s: torch.randn(*s, dtype=torch.bfloat16) * 1.6)(S, F) * (S ** -0.5)),
            "b1": _w((lambda *s: torch.randn(*s, dtype=torch.bfloat16) * 1.6)(F) * 0.02),
            "w2": _w((lambda *s: torch.randn(*s, dtype=torch.bfloat16) * 1.6)(F, S) * (F ** -0.5)),
            "b2": _w((lambda *s: torch.randn(*s, dtype=torch.bfloat16) * 1.6)(S) * 0.02),
        }
    _B_in = _B_setup()

    return {
        "A_x": _A_in["x"],
        "A_k_cache": _A_in["k_cache"],
        "A_v_cache": _A_in["v_cache"],
        "A_wq": _A_in["wq"],
        "A_wo": _A_in["wo"],
        "B_x": _B_in["x"],
        "B_w1": _B_in["w1"],
        "B_b1": _B_in["b1"],
        "B_w2": _B_in["w2"],
        "B_b2": _B_in["b2"],
    }

def reference(A_x, A_k_cache, A_v_cache, A_wq, A_wo, B_x, B_w1, B_b1, B_w2, B_b2):
    def _A_ref(x, k_cache, v_cache, wq, wo):
        B, Sq, D = x.shape
        Hq, Dh = 32, 128
        Hkv = k_cache.shape[1]
        rep = Hq // Hkv
        q = (lambda x, *d: x.permute(*d))((x @ wq).reshape(B, Sq, Hq, Dh), 0, 2, 1, 3)
        k = (lambda x, n, axis: torch.repeat_interleave(x, n, dim=axis))(k_cache, rep, axis=1)
        v = (lambda x, n, axis: torch.repeat_interleave(x, n, dim=axis))(v_cache, rep, axis=1)
        scores = torch.einsum("bhqd,bhkd->bhqk", q, k) * (Dh ** -0.5)
        p = _softmax(scores, axis=-1)
        o = torch.einsum("bhqk,bhkd->bhqd", p, v)
        return (lambda x, *d: x.permute(*d))(o, 0, 2, 1, 3).reshape(B, Sq, Hq * Dh) @ wo

    def _B_ref(x, w1, b1, w2, b2):
        B, S, D = x.shape
        h = _layernorm(x, axis=-1)
        u = torch.einsum("bsd,sf->bdf", h, w1) + b1
        u = _gelu(u)
        y = torch.einsum("bdf,fs->bds", u, w2) + b2
        return (lambda x, *d: x.permute(*d))(y, 0, 2, 1)

    x = A_x
    xn = _layernorm(x, axis=-1)
    s = _A_ref(xn, A_k_cache, A_v_cache, A_wq, A_wo)
    g = _silu(_B_ref(xn, B_w1, B_b1, B_w2, B_b2))
    return x + s * g
```

```asm
; @launch grid=(256,1,1) block=(256,1,1) lds=12544
.amdgcn_target "amdgcn-amd-amdhsa--gfx950"
.text
.globl recurrent_scan__gqa_block_cached__mixer_token_mlp__decode_kernel
.p2align 8
.type recurrent_scan__gqa_block_cached__mixer_token_mlp__decode_kernel,@function
recurrent_scan__gqa_block_cached__mixer_token_mlp__decode_kernel:
  s_cmp_ge_u32 s2, 256
  s_cbranch_scc1 L_end
  s_load_dwordx16 s[16:31], s[0:1], 0
  s_load_dwordx8 s[32:39], s[0:1], 64
  s_load_dwordx2 s[40:41], s[0:1], 96
  v_and_b32 v1, 63, v0
  v_lshrrev_b32 v46, 6, v0
  s_and_b32 s73, s2, 7
  v_readfirstlane_b32 s72, v46
  s_lshr_b32 s74, s2, 3
  v_lshlrev_b32 v3, 4, v1
  s_and_b32 s75, s74, 7
  s_lshr_b32 s81, s74, 3
  s_lshl_b32 s82, s81, 3
  s_add_u32 s76, s82, s73
  s_mov_b32 s98, 0x3fb8aa3b
  s_mov_b32 s77, 0
  s_cmp_lg_u32 s72, 0
  s_cbranch_scc1 L_stream
  v_lshrrev_b32 v46, 3, v1
  v_lshlrev_b32 v46, 17, v46
  v_and_b32 v47, 7, v1
  v_lshl_add_u32 v46, v47, 4, v46
  s_lshl_b32 s83, s73, 3
  s_add_u32 s85, s83, s75
  s_lshl_b32 s83, s85, 7
  s_lshl_b32 s84, s81, 20
  s_add_u32 s83, s83, s84
  v_add_u32 v62, s83, v46
  v_add_u32 v63, 0x2000, v62
  s_lshl_b32 s83, s73, 2
  s_and_b32 s84, s75, 3
  s_add_u32 s83, s83, s84
  s_mul_i32 s83, s83, 1280
  s_add_u32 s83, s83, 65536
  v_mov_b32 v55, s83
  v_mov_b32 v56, 0x10000
  v_and_b32 v73, 1, v1
  v_mul_u32_u24 v73, 3112960, v73
  v_add_u32 v73, 32768, v73
  s_waitcnt lgkmcnt(0)
  global_load_dwordx4 v[104:107], v3, s[16:17]
  global_load_dword v73, v73, s[40:41] sc1
  global_load_dwordx4 v[108:111], v62, s[22:23] nt
  global_load_dwordx4 v[112:115], v63, s[22:23] nt
  v_add_u32 v62, 0x4000, v62
  v_add_u32 v63, 0x4000, v63
  global_load_dwordx4 v[116:119], v62, s[22:23] nt
  global_load_dwordx4 v[120:123], v63, s[22:23] nt
  v_add_u32 v62, 0x4000, v62
  v_add_u32 v63, 0x4000, v63
  global_load_dwordx4 v[124:127], v62, s[22:23] nt
  global_load_dwordx4 v[128:131], v63, s[22:23] nt
  v_add_u32 v62, 0x4000, v62
  v_add_u32 v63, 0x4000, v63
  global_load_dwordx4 v[132:135], v62, s[22:23] nt
  global_load_dwordx4 v[136:139], v63, s[22:23] nt
  v_add_u32 v62, 0x4000, v62
  v_add_u32 v63, 0x4000, v63
  s_mov_b64 exec, 1
  global_store_dword v55, v56, s[40:41] sc1
  s_mov_b64 exec, -1
  global_load_dwordx4 v[140:143], v62, s[22:23] nt
  global_load_dwordx4 v[144:147], v63, s[22:23] nt
  v_add_u32 v62, 0x4000, v62
  v_add_u32 v63, 0x4000, v63
  global_load_dwordx4 v[148:151], v62, s[22:23] nt
  global_load_dwordx4 v[152:155], v63, s[22:23] nt
  v_add_u32 v62, 0x4000, v62
  v_add_u32 v63, 0x4000, v63
  global_load_dwordx4 v[156:159], v62, s[22:23] nt
  global_load_dwordx4 v[160:163], v63, s[22:23] nt
  v_add_u32 v62, 0x4000, v62
  v_add_u32 v63, 0x4000, v63
  global_load_dwordx4 v[164:167], v62, s[22:23] nt
  global_load_dwordx4 v[168:171], v63, s[22:23] nt
  s_barrier
  s_lshl_b32 s83, s73, 2
  s_add_u32 s83, s83, s81
  s_lshl_b32 s83, s83, 3
  s_add_u32 s83, s83, s75
  s_lshl_b32 s83, s83, 9
  s_add_u32 s83, s83, 262144
  v_and_b32 v46, 7, v1
  v_lshrrev_b32 v47, 4, v1
  v_lshl_add_u32 v46, v46, 2, v47
  v_lshl_add_u32 v67, v46, 4, s83
  s_lshl_b32 s84, s75, 14
  s_add_u32 s84, s84, 262144
  v_add_u32 v68, s84, v3
  v_add_u32 v69, 0x1000, v68
  v_add_u32 v70, 0x2000, v68
  v_add_u32 v71, 0x3000, v68
  v_and_b32 v46, 31, v1
  v_lshl_add_u32 v72, v46, 9, s84
  s_lshl_b32 s90, s73, 6
  s_lshl_b32 s83, s74, 1
  s_add_u32 s90, s90, s83
  s_waitcnt vmcnt(18)
  v_lshlrev_b32 v38, 16, v104
  v_and_b32 v39, 0xffff0000, v104
  v_lshlrev_b32 v40, 16, v105
  v_and_b32 v41, 0xffff0000, v105
  v_lshlrev_b32 v42, 16, v106
  v_and_b32 v43, 0xffff0000, v106
  v_lshlrev_b32 v44, 16, v107
  v_and_b32 v45, 0xffff0000, v107
  v_add_f32 v34, v38, v39
  v_add_f32 v35, v40, v41
  v_add_f32 v36, v42, v43
  v_add_f32 v37, v44, v45
  v_add_f32 v34, v34, v35
  v_add_f32 v36, v36, v37
  v_add_f32 v34, v34, v36
  s_nop 1
  v_add_f32_dpp v34, v34, v34 quad_perm:[1,0,3,2] row_mask:0xf bank_mask:0xf
  s_nop 1
  v_add_f32_dpp v34, v34, v34 quad_perm:[2,3,0,1] row_mask:0xf bank_mask:0xf
  s_nop 1
  v_add_f32_dpp v34, v34, v34 row_half_mirror row_mask:0xf bank_mask:0xf
  s_nop 1
  v_add_f32_dpp v34, v34, v34 row_mirror row_mask:0xf bank_mask:0xf
  v_mov_b32 v37, v34
  s_nop 1
  v_permlane16_swap_b32 v34, v37
  s_nop 0
  v_add_f32 v34, v34, v37
  v_mov_b32 v37, v34
  s_nop 1
  v_permlane32_swap_b32 v34, v37
  s_nop 0
  v_add_f32 v34, v34, v37
  v_mul_f32 v34, 0x3b000000, v34
  v_sub_f32 v36, v38, v34
  v_mul_f32 v35, v36, v36
  v_sub_f32 v36, v39, v34
  v_fmac_f32 v35, v36, v36
  v_sub_f32 v36, v40, v34
  v_fmac_f32 v35, v36, v36
  v_sub_f32 v36, v41, v34
  v_fmac_f32 v35, v36, v36
  v_sub_f32 v36, v42, v34
  v_fmac_f32 v35, v36, v36
  v_sub_f32 v36, v43, v34
  v_fmac_f32 v35, v36, v36
  v_sub_f32 v36, v44, v34
  v_fmac_f32 v35, v36, v36
  v_sub_f32 v36, v45, v34
  v_fmac_f32 v35, v36, v36
  s_nop 1
  v_add_f32_dpp v35, v35, v35 quad_perm:[1,0,3,2] row_mask:0xf bank_mask:0xf
  s_nop 1
  v_add_f32_dpp v35, v35, v35 quad_perm:[2,3,0,1] row_mask:0xf bank_mask:0xf
  s_nop 1
  v_add_f32_dpp v35, v35, v35 row_half_mirror row_mask:0xf bank_mask:0xf
  s_nop 1
  v_add_f32_dpp v35, v35, v35 row_mirror row_mask:0xf bank_mask:0xf
  v_mov_b32 v37, v35
  s_nop 1
  v_permlane16_swap_b32 v35, v37
  s_nop 0
  v_add_f32 v35, v35, v37
  v_mov_b32 v37, v35
  s_nop 1
  v_permlane32_swap_b32 v35, v37
  s_nop 0
  v_add_f32 v35, v35, v37
  v_mul_f32 v35, 0x3b000000, v35
  v_cvt_pk_bf16_f32 v35, v34, v35
  v_lshlrev_b32 v34, 16, v35
  v_and_b32 v35, 0xffff0000, v35
  v_add_f32 v35, 0x3727c5ac, v35
  v_cvt_pk_bf16_f32 v35, v35, v35
  v_and_b32 v35, 0xffff0000, v35
  v_sqrt_f32 v36, v35
  s_nop 0
  v_rcp_f32 v37, v36
  v_fma_f32 v46, -v36, v36, v35
  v_mul_f32 v37, 0.5, v37
  v_fma_f32 v35, v46, v37, v36
  v_cvt_pk_bf16_f32 v35, v35, v35
  v_and_b32 v35, 0xffff0000, v35
  v_rcp_f32 v36, v35
  s_nop 0
  v_fma_f32 v37, -v35, v36, 1.0
  v_fma_f32 v36, v37, v36, v36
  v_sub_f32 v38, v38, v34
  v_sub_f32 v39, v39, v34
  v_cvt_pk_bf16_f32 v39, v38, v39
  v_lshlrev_b32 v38, 16, v39
  v_and_b32 v39, 0xffff0000, v39
  v_mul_f32 v46, v38, v36
  v_fma_f32 v38, -v46, v35, v38
  v_fma_f32 v38, v38, v36, v46
  v_mul_f32 v46, v39, v36
  v_fma_f32 v39, -v46, v35, v39
  v_fma_f32 v39, v39, v36, v46
  v_cvt_pk_bf16_f32 v104, v38, v39
  v_sub_f32 v40, v40, v34
  v_sub_f32 v41, v41, v34
  v_cvt_pk_bf16_f32 v41, v40, v41
  v_lshlrev_b32 v40, 16, v41
  v_and_b32 v41, 0xffff0000, v41
  v_mul_f32 v46, v40, v36
  v_fma_f32 v40, -v46, v35, v40
  v_fma_f32 v40, v40, v36, v46
  v_mul_f32 v46, v41, v36
  v_fma_f32 v41, -v46, v35, v41
  v_fma_f32 v41, v41, v36, v46
  v_cvt_pk_bf16_f32 v105, v40, v41
  v_sub_f32 v42, v42, v34
  v_sub_f32 v43, v43, v34
  v_cvt_pk_bf16_f32 v43, v42, v43
  v_lshlrev_b32 v42, 16, v43
  v_and_b32 v43, 0xffff0000, v43
  v_mul_f32 v46, v42, v36
  v_fma_f32 v42, -v46, v35, v42
  v_fma_f32 v42, v42, v36, v46
  v_mul_f32 v46, v43, v36
  v_fma_f32 v43, -v46, v35, v43
  v_fma_f32 v43, v43, v36, v46
  v_cvt_pk_bf16_f32 v106, v42, v43
  v_sub_f32 v44, v44, v34
  v_sub_f32 v45, v45, v34
  v_cvt_pk_bf16_f32 v45, v44, v45
  v_lshlrev_b32 v44, 16, v45
  v_and_b32 v45, 0xffff0000, v45
  v_mul_f32 v46, v44, v36
  v_fma_f32 v44, -v46, v35, v44
  v_fma_f32 v44, v44, v36, v46
  v_mul_f32 v46, v45, v36
  v_fma_f32 v45, -v46, v35, v45
  v_fma_f32 v45, v45, v36, v46
  v_cvt_pk_bf16_f32 v107, v44, v45
  ds_write_b128 v3, v[104:107] offset:0
  s_mov_b32 s83, 0x05040100
  s_mov_b32 s84, 0x07060302
  v_lshrrev_b32 v47, 3, v1
  s_lshl_b32 s82, s81, 8
  v_lshl_add_u32 v47, v47, 5, s82
  ds_read_b128 v[38:41], v47 offset:0
  ds_read_b128 v[42:45], v47 offset:16
  s_waitcnt vmcnt(15)
  v_perm_b32 v12, v112, v108, s83
  v_perm_b32 v13, v112, v108, s84
  v_perm_b32 v14, v113, v109, s83
  v_perm_b32 v15, v113, v109, s84
  v_perm_b32 v16, v114, v110, s83
  v_perm_b32 v17, v114, v110, s84
  v_perm_b32 v18, v115, v111, s83
  v_perm_b32 v19, v115, v111, s84
  s_waitcnt lgkmcnt(0)
  v_dot2_f32_bf16 v4, v12, v38, 0
  v_dot2_f32_bf16 v5, v13, v38, 0
  v_dot2_f32_bf16 v6, v14, v38, 0
  v_dot2_f32_bf16 v7, v15, v38, 0
  v_dot2_f32_bf16 v8, v16, v38, 0
  v_dot2_f32_bf16 v9, v17, v38, 0
  v_dot2_f32_bf16 v10, v18, v38, 0
  v_dot2_f32_bf16 v11, v19, v38, 0
  s_waitcnt vmcnt(13)
  v_perm_b32 v12, v120, v116, s83
  v_perm_b32 v13, v120, v116, s84
  v_perm_b32 v14, v121, v117, s83
  v_perm_b32 v15, v121, v117, s84
  v_perm_b32 v16, v122, v118, s83
  v_perm_b32 v17, v122, v118, s84
  v_perm_b32 v18, v123, v119, s83
  v_perm_b32 v19, v123, v119, s84
  v_dot2_f32_bf16 v4, v12, v39, v4
  v_dot2_f32_bf16 v5, v13, v39, v5
  v_dot2_f32_bf16 v6, v14, v39, v6
  v_dot2_f32_bf16 v7, v15, v39, v7
  v_dot2_f32_bf16 v8, v16, v39, v8
  v_dot2_f32_bf16 v9, v17, v39, v9
  v_dot2_f32_bf16 v10, v18, v39, v10
  v_dot2_f32_bf16 v11, v19, v39, v11
  s_waitcnt vmcnt(11)
  v_perm_b32 v12, v128, v124, s83
  v_perm_b32 v13, v128, v124, s84
  v_perm_b32 v14, v129, v125, s83
  v_perm_b32 v15, v129, v125, s84
  v_perm_b32 v16, v130, v126, s83
  v_perm_b32 v17, v130, v126, s84
  v_perm_b32 v18, v131, v127, s83
  v_perm_b32 v19, v131, v127, s84
  v_dot2_f32_bf16 v4, v12, v40, v4
  v_dot2_f32_bf16 v5, v13, v40, v5
  v_dot2_f32_bf16 v6, v14, v40, v6
  v_dot2_f32_bf16 v7, v15, v40, v7
  v_dot2_f32_bf16 v8, v16, v40, v8
  v_dot2_f32_bf16 v9, v17, v40, v9
  v_dot2_f32_bf16 v10, v18, v40, v10
  v_dot2_f32_bf16 v11, v19, v40, v11
  s_waitcnt vmcnt(9)
  v_perm_b32 v12, v136, v132, s83
  v_perm_b32 v13, v136, v132, s84
  v_perm_b32 v14, v137, v133, s83
  v_perm_b32 v15, v137, v133, s84
  v_perm_b32 v16, v138, v134, s83
  v_perm_b32 v17, v138, v134, s84
  v_perm_b32 v18, v139, v135, s83
  v_perm_b32 v19, v139, v135, s84
  v_dot2_f32_bf16 v4, v12, v41, v4
  v_dot2_f32_bf16 v5, v13, v41, v5
  v_dot2_f32_bf16 v6, v14, v41, v6
  v_dot2_f32_bf16 v7, v15, v41, v7
  v_dot2_f32_bf16 v8, v16, v41, v8
  v_dot2_f32_bf16 v9, v17, v41, v9
  v_dot2_f32_bf16 v10, v18, v41, v10
  v_dot2_f32_bf16 v11, v19, v41, v11
  s_waitcnt vmcnt(6)
  v_perm_b32 v12, v144, v140, s83
  v_perm_b32 v13, v144, v140, s84
  v_perm_b32 v14, v145, v141, s83
  v_perm_b32 v15, v145, v141, s84
  v_perm_b32 v16, v146, v142, s83
  v_perm_b32 v17, v146, v142, s84
  v_perm_b32 v18, v147, v143, s83
  v_perm_b32 v19, v147, v143, s84
  v_dot2_f32_bf16 v4, v12, v42, v4
  v_dot2_f32_bf16 v5, v13, v42, v5
  v_dot2_f32_bf16 v6, v14, v42, v6
  v_dot2_f32_bf16 v7, v15, v42, v7
  v_dot2_f32_bf16 v8, v16, v42, v8
  v_dot2_f32_bf16 v9, v17, v42, v9
  v_dot2_f32_bf16 v10, v18, v42, v10
  v_dot2_f32_bf16 v11, v19, v42, v11
  s_waitcnt vmcnt(4)
  v_perm_b32 v12, v152, v148, s83
  v_perm_b32 v13, v152, v148, s84
  v_perm_b32 v14, v153, v149, s83
  v_perm_b32 v15, v153, v149, s84
  v_perm_b32 v16, v154, v150, s83
  v_perm_b32 v17, v154, v150, s84
  v_perm_b32 v18, v155, v151, s83
  v_perm_b32 v19, v155, v151, s84
  v_dot2_f32_bf16 v4, v12, v43, v4
  v_dot2_f32_bf16 v5, v13, v43, v5
  v_dot2_f32_bf16 v6, v14, v43, v6
  v_dot2_f32_bf16 v7, v15, v43, v7
  v_dot2_f32_bf16 v8, v16, v43, v8
  v_dot2_f32_bf16 v9, v17, v43, v9
  v_dot2_f32_bf16 v10, v18, v43, v10
  v_dot2_f32_bf16 v11, v19, v43, v11
  s_waitcnt vmcnt(2)
  v_perm_b32 v12, v160, v156, s83
  v_perm_b32 v13, v160, v156, s84
  v_perm_b32 v14, v161, v157, s83
  v_perm_b32 v15, v161, v157, s84
  v_perm_b32 v16, v162, v158, s83
  v_perm_b32 v17, v162, v158, s84
  v_perm_b32 v18, v163, v159, s83
  v_perm_b32 v19, v163, v159, s84
  v_dot2_f32_bf16 v4, v12, v44, v4
  v_dot2_f32_bf16 v5, v13, v44, v5
  v_dot2_f32_bf16 v6, v14, v44, v6
  v_dot2_f32_bf16 v7, v15, v44, v7
  v_dot2_f32_bf16 v8, v16, v44, v8
  v_dot2_f32_bf16 v9, v17, v44, v9
  v_dot2_f32_bf16 v10, v18, v44, v10
  v_dot2_f32_bf16 v11, v19, v44, v11
  s_waitcnt vmcnt(0)
  v_perm_b32 v12, v168, v164, s83
  v_perm_b32 v13, v168, v164, s84
  v_perm_b32 v14, v169, v165, s83
  v_perm_b32 v15, v169, v165, s84
  v_perm_b32 v16, v170, v166, s83
  v_perm_b32 v17, v170, v166, s84
  v_perm_b32 v18, v171, v167, s83
  v_perm_b32 v19, v171, v167, s84
  v_dot2_f32_bf16 v4, v12, v45, v4
  v_dot2_f32_bf16 v5, v13, v45, v5
  v_dot2_f32_bf16 v6, v14, v45, v6
  v_dot2_f32_bf16 v7, v15, v45, v7
  v_dot2_f32_bf16 v8, v16, v45, v8
  v_dot2_f32_bf16 v9, v17, v45, v9
  v_dot2_f32_bf16 v10, v18, v45, v10
  v_dot2_f32_bf16 v11, v19, v45, v11
  v_readlane_b32 s42, v73, 0
  v_readlane_b32 s43, v73, 1
  s_mul_i32 s42, s42, 1664525
  s_add_u32 s42, s42, 1013904223
  s_mul_i32 s43, s43, 1664525
  s_add_u32 s43, s43, 2891336453
  s_and_b32 s61, s42, 0xffff0000
  v_permlane32_swap_b32 v4, v8
  v_permlane32_swap_b32 v5, v9
  v_permlane32_swap_b32 v6, v10
  v_permlane32_swap_b32 v7, v11
  s_nop 0
  v_add_f32 v4, v4, v8
  v_add_f32 v5, v5, v9
  v_add_f32 v6, v6, v10
  v_add_f32 v7, v7, v11
  s_nop 0
  v_permlane16_swap_b32 v4, v6
  v_permlane16_swap_b32 v5, v7
  s_nop 0
  v_add_f32 v4, v4, v6
  v_add_f32 v5, v5, v7
  v_mov_b32 v6, s42
  v_add_f32_dpp v4, v4, v4 row_ror:8 row_mask:0xf bank_mask:0xf
  v_add_f32_dpp v5, v5, v5 row_ror:8 row_mask:0xf bank_mask:0xf
  v_mov_b32 v7, s43
  s_mov_b32 exec_lo, 0x00ff00ff
  s_mov_b32 exec_hi, 0x00ff00ff
  global_store_dwordx4 v67, v[4:7], s[40:41] sc1
  s_mov_b64 exec, -1
  v_mov_b32 v46, 0
  ds_write_b64 v46, v[6:7] offset:2176
  v_lshlrev_b32 v38, 16, v104
  v_and_b32 v39, 0xffff0000, v104
  v_lshlrev_b32 v40, 16, v105
  v_and_b32 v41, 0xffff0000, v105
  v_lshlrev_b32 v42, 16, v106
  v_and_b32 v43, 0xffff0000, v106
  v_lshlrev_b32 v44, 16, v107
  v_and_b32 v45, 0xffff0000, v107
  v_add_f32 v34, v38, v39
  v_add_f32 v35, v40, v41
  v_add_f32 v36, v42, v43
  v_add_f32 v37, v44, v45
  v_add_f32 v34, v34, v35
  v_add_f32 v36, v36, v37
  v_add_f32 v34, v34, v36
  s_nop 1
  v_add_f32_dpp v34, v34, v34 quad_perm:[1,0,3,2] row_mask:0xf bank_mask:0xf
  s_nop 1
  v_add_f32_dpp v34, v34, v34 quad_perm:[2,3,0,1] row_mask:0xf bank_mask:0xf
  s_nop 1
  v_add_f32_dpp v34, v34, v34 row_half_mirror row_mask:0xf bank_mask:0xf
  s_nop 1
  v_add_f32_dpp v34, v34, v34 row_mirror row_mask:0xf bank_mask:0xf
  v_mov_b32 v37, v34
  s_nop 1
  v_permlane16_swap_b32 v34, v37
  s_nop 0
  v_add_f32 v34, v34, v37
  v_mov_b32 v37, v34
  s_nop 1
  v_permlane32_swap_b32 v34, v37
  s_nop 0
  v_add_f32 v34, v34, v37
  v_mul_f32 v34, 0x3b000000, v34
  v_sub_f32 v36, v38, v34
  v_mul_f32 v35, v36, v36
  v_sub_f32 v36, v39, v34
  v_fmac_f32 v35, v36, v36
  v_sub_f32 v36, v40, v34
  v_fmac_f32 v35, v36, v36
  v_sub_f32 v36, v41, v34
  v_fmac_f32 v35, v36, v36
  v_sub_f32 v36, v42, v34
  v_fmac_f32 v35, v36, v36
  v_sub_f32 v36, v43, v34
  v_fmac_f32 v35, v36, v36
  v_sub_f32 v36, v44, v34
  v_fmac_f32 v35, v36, v36
  v_sub_f32 v36, v45, v34
  v_fmac_f32 v35, v36, v36
  s_nop 1
  v_add_f32_dpp v35, v35, v35 quad_perm:[1,0,3,2] row_mask:0xf bank_mask:0xf
  s_nop 1
  v_add_f32_dpp v35, v35, v35 quad_perm:[2,3,0,1] row_mask:0xf bank_mask:0xf
  s_nop 1
  v_add_f32_dpp v35, v35, v35 row_half_mirror row_mask:0xf bank_mask:0xf
  s_nop 1
  v_add_f32_dpp v35, v35, v35 row_mirror row_mask:0xf bank_mask:0xf
  v_mov_b32 v37, v35
  s_nop 1
  v_permlane16_swap_b32 v35, v37
  s_nop 0
  v_add_f32 v35, v35, v37
  v_mov_b32 v37, v35
  s_nop 1
  v_permlane32_swap_b32 v35, v37
  s_nop 0
  v_add_f32 v35, v35, v37
  v_mul_f32 v35, 0x3b000000, v35
  v_cvt_pk_bf16_f32 v35, v34, v35
  v_lshlrev_b32 v34, 16, v35
  v_and_b32 v35, 0xffff0000, v35
  v_add_f32 v35, 0x3727c5ac, v35
  v_cvt_pk_bf16_f32 v35, v35, v35
  v_and_b32 v35, 0xffff0000, v35
  v_sqrt_f32 v36, v35
  s_nop 0
  v_rcp_f32 v37, v36
  v_fma_f32 v46, -v36, v36, v35
  v_mul_f32 v37, 0.5, v37
  v_fma_f32 v35, v46, v37, v36
  v_cvt_pk_bf16_f32 v35, v35, v35
  v_and_b32 v35, 0xffff0000, v35
  v_rcp_f32 v36, v35
  s_nop 0
  v_fma_f32 v37, -v35, v36, 1.0
  v_fma_f32 v36, v37, v36, v36
  s_lshl_b32 s84, s90, 1
  v_mov_b32 v47, s84
  ds_read_b32 v50, v47 offset:0
  s_load_dword s88, s[16:17], s84
  s_waitcnt lgkmcnt(0)
  v_lshlrev_b32 v232, 16, v50
  v_and_b32 v233, 0xffff0000, v50
  v_sub_f32 v232, v232, v34
  v_sub_f32 v233, v233, v34
  v_cvt_pk_bf16_f32 v233, v232, v233
  v_lshlrev_b32 v232, 16, v233
  v_and_b32 v233, 0xffff0000, v233
  v_mul_f32 v46, v232, v36
  v_fma_f32 v232, -v46, v35, v232
  v_fma_f32 v232, v232, v36, v46
  v_mul_f32 v46, v233, v36
  v_fma_f32 v233, -v46, v35, v233
  v_fma_f32 v233, v233, v36, v46
  v_cvt_pk_bf16_f32 v233, v232, v233
  v_lshlrev_b32 v232, 16, v233
  v_and_b32 v233, 0xffff0000, v233
  s_mov_b32 s85, 0
  s_waitcnt vmcnt(0)
  global_load_dwordx4 v[112:115], v68, s[40:41] offset:0 sc1
  global_load_dwordx4 v[116:119], v68, s[40:41] offset:1024 sc1
  global_load_dwordx4 v[120:123], v68, s[40:41] offset:2048 sc1
  global_load_dwordx4 v[124:127], v68, s[40:41] offset:3072 sc1
  global_load_dwordx4 v[128:131], v69, s[40:41] offset:0 sc1
  global_load_dwordx4 v[132:135], v69, s[40:41] offset:1024 sc1
  global_load_dwordx4 v[136:139], v69, s[40:41] offset:2048 sc1
  global_load_dwordx4 v[140:143], v69, s[40:41] offset:3072 sc1
  global_load_dwordx4 v[144:147], v70, s[40:41] offset:0 sc1
  global_load_dwordx4 v[148:151], v70, s[40:41] offset:1024 sc1
  global_load_dwordx4 v[152:155], v70, s[40:41] offset:2048 sc1
  global_load_dwordx4 v[156:159], v70, s[40:41] offset:3072 sc1
  global_load_dwordx4 v[160:163], v71, s[40:41] offset:0 sc1
  global_load_dwordx4 v[164:167], v71, s[40:41] offset:1024 sc1
  global_load_dwordx4 v[168:171], v71, s[40:41] offset:2048 sc1
  global_load_dwordx4 v[172:175], v71, s[40:41] offset:3072 sc1
L_pollQ:
  s_mov_b32 s62, 0
  s_waitcnt vmcnt(0)
  v_xor_b32 v47, s42, v114
  v_xor_b32 v48, s43, v115
  v_or_b32 v46, v47, v48
  v_cmp_ne_u32 vcc, 0, v46
  s_cbranch_vccz L_pq0
  s_mov_b64 exec, vcc
  global_load_dwordx4 v[112:115], v68, s[40:41] offset:0 sc1
  s_mov_b64 exec, -1
  s_mov_b32 s62, 1
L_pq0:
  v_xor_b32 v47, s42, v118
  v_xor_b32 v48, s43, v119
  v_or_b32 v46, v47, v48
  v_cmp_ne_u32 vcc, 0, v46
  s_cbranch_vccz L_pq1
  s_mov_b64 exec, vcc
  global_load_dwordx4 v[116:119], v68, s[40:41] offset:1024 sc1
  s_mov_b64 exec, -1
  s_mov_b32 s62, 1
L_pq1:
  v_xor_b32 v47, s42, v122
  v_xor_b32 v48, s43, v123
  v_or_b32 v46, v47, v48
  v_cmp_ne_u32 vcc, 0, v46
  s_cbranch_vccz L_pq2
  s_mov_b64 exec, vcc
  global_load_dwordx4 v[120:123], v68, s[40:41] offset:2048 sc1
  s_mov_b64 exec, -1
  s_mov_b32 s62, 1
L_pq2:
  v_xor_b32 v47, s42, v126
  v_xor_b32 v48, s43, v127
  v_or_b32 v46, v47, v48
  v_cmp_ne_u32 vcc, 0, v46
  s_cbranch_vccz L_pq3
  s_mov_b64 exec, vcc
  global_load_dwordx4 v[124:127], v68, s[40:41] offset:3072 sc1
  s_mov_b64 exec, -1
  s_mov_b32 s62, 1
L_pq3:
  v_xor_b32 v47, s42, v130
  v_xor_b32 v48, s43, v131
  v_or_b32 v46, v47, v48
  v_cmp_ne_u32 vcc, 0, v46
  s_cbranch_vccz L_pq4
  s_mov_b64 exec, vcc
  global_load_dwordx4 v[128:131], v69, s[40:41] offset:0 sc1
  s_mov_b64 exec, -1
  s_mov_b32 s62, 1
L_pq4:
  v_xor_b32 v47, s42, v134
  v_xor_b32 v48, s43, v135
  v_or_b32 v46, v47, v48
  v_cmp_ne_u32 vcc, 0, v46
  s_cbranch_vccz L_pq5
  s_mov_b64 exec, vcc
  global_load_dwordx4 v[132:135], v69, s[40:41] offset:1024 sc1
  s_mov_b64 exec, -1
  s_mov_b32 s62, 1
L_pq5:
  v_xor_b32 v47, s42, v138
  v_xor_b32 v48, s43, v139
  v_or_b32 v46, v47, v48
  v_cmp_ne_u32 vcc, 0, v46
  s_cbranch_vccz L_pq6
  s_mov_b64 exec, vcc
  global_load_dwordx4 v[136:139], v69, s[40:41] offset:2048 sc1
  s_mov_b64 exec, -1
  s_mov_b32 s62, 1
L_pq6:
  v_xor_b32 v47, s42, v142
  v_xor_b32 v48, s43, v143
  v_or_b32 v46, v47, v48
  v_cmp_ne_u32 vcc, 0, v46
  s_cbranch_vccz L_pq7
  s_mov_b64 exec, vcc
  global_load_dwordx4 v[140:143], v69, s[40:41] offset:3072 sc1
  s_mov_b64 exec, -1
  s_mov_b32 s62, 1
L_pq7:
  v_xor_b32 v47, s42, v146
  v_xor_b32 v48, s43, v147
  v_or_b32 v46, v47, v48
  v_cmp_ne_u32 vcc, 0, v46
  s_cbranch_vccz L_pq8
  s_mov_b64 exec, vcc
  global_load_dwordx4 v[144:147], v70, s[40:41] offset:0 sc1
  s_mov_b64 exec, -1
  s_mov_b32 s62, 1
L_pq8:
  v_xor_b32 v47, s42, v150
  v_xor_b32 v48, s43, v151
  v_or_b32 v46, v47, v48
  v_cmp_ne_u32 vcc, 0, v46
  s_cbranch_vccz L_pq9
  s_mov_b64 exec, vcc
  global_load_dwordx4 v[148:151], v70, s[40:41] offset:1024 sc1
  s_mov_b64 exec, -1
  s_mov_b32 s62, 1
L_pq9:
  v_xor_b32 v47, s42, v154
  v_xor_b32 v48, s43, v155
  v_or_b32 v46, v47, v48
  v_cmp_ne_u32 vcc, 0, v46
  s_cbranch_vccz L_pq10
  s_mov_b64 exec, vcc
  global_load_dwordx4 v[152:155], v70, s[40:41] offset:2048 sc1
  s_mov_b64 exec, -1
  s_mov_b32 s62, 1
L_pq10:
  v_xor_b32 v47, s42, v158
  v_xor_b32 v48, s43, v159
  v_or_b32 v46, v47, v48
  v_cmp_ne_u32 vcc, 0, v46
  s_cbranch_vccz L_pq11
  s_mov_b64 exec, vcc
  global_load_dwordx4 v[156:159], v70, s[40:41] offset:3072 sc1
  s_mov_b64 exec, -1
  s_mov_b32 s62, 1
L_pq11:
  v_xor_b32 v47, s42, v162
  v_xor_b32 v48, s43, v163
  v_or_b32 v46, v47, v48
  v_cmp_ne_u32 vcc, 0, v46
  s_cbranch_vccz L_pq12
  s_mov_b64 exec, vcc
  global_load_dwordx4 v[160:163], v71, s[40:41] offset:0 sc1
  s_mov_b64 exec, -1
  s_mov_b32 s62, 1
L_pq12:
  v_xor_b32 v47, s42, v166
  v_xor_b32 v48, s43, v167
  v_or_b32 v46, v47, v48
  v_cmp_ne_u32 vcc, 0, v46
  s_cbranch_vccz L_pq13
  s_mov_b64 exec, vcc
  global_load_dwordx4 v[164:167], v71, s[40:41] offset:1024 sc1
  s_mov_b64 exec, -1
  s_mov_b32 s62, 1
L_pq13:
  v_xor_b32 v47, s42, v170
  v_xor_b32 v48, s43, v171
  v_or_b32 v46, v47, v48
  v_cmp_ne_u32 vcc, 0, v46
  s_cbranch_vccz L_pq14
  s_mov_b64 exec, vcc
  global_load_dwordx4 v[168:171], v71, s[40:41] offset:2048 sc1
  s_mov_b64 exec, -1
  s_mov_b32 s62, 1
L_pq14:
  v_xor_b32 v47, s42, v174
  v_xor_b32 v48, s43, v175
  v_or_b32 v46, v47, v48
  v_cmp_ne_u32 vcc, 0, v46
  s_cbranch_vccz L_pq15
  s_mov_b64 exec, vcc
  global_load_dwordx4 v[172:175], v71, s[40:41] offset:3072 sc1
  s_mov_b64 exec, -1
  s_mov_b32 s62, 1
L_pq15:
  s_cmp_eq_u32 s62, 0
  s_cbranch_scc1 L_pollQ_done
  s_sleep 12
  s_add_u32 s85, s85, 1
  s_cmp_lt_u32 s85, 4000000
  s_cbranch_scc1 L_pollQ
L_pollQ_done:
  s_mov_b64 exec, -1
  v_lshlrev_b32 v46, 2, v1
  v_add_f32 v112, v112, v128
  v_add_f32 v144, v144, v160
  v_add_f32 v112, v112, v144
  v_add_f32 v113, v113, v129
  v_add_f32 v145, v145, v161
  v_add_f32 v113, v113, v145
  v_cvt_pk_bf16_f32 v112, v112, v113
  ds_write_b32 v46, v112 offset:1024
  v_add_f32 v116, v116, v132
  v_add_f32 v148, v148, v164
  v_add_f32 v116, v116, v148
  v_add_f32 v117, v117, v133
  v_add_f32 v149, v149, v165
  v_add_f32 v117, v117, v149
  v_cvt_pk_bf16_f32 v116, v116, v117
  ds_write_b32 v46, v116 offset:1280
  v_add_f32 v120, v120, v136
  v_add_f32 v152, v152, v168
  v_add_f32 v120, v120, v152
  v_add_f32 v121, v121, v137
  v_add_f32 v153, v153, v169
  v_add_f32 v121, v121, v153
  v_cvt_pk_bf16_f32 v120, v120, v121
  ds_write_b32 v46, v120 offset:1536
  v_add_f32 v124, v124, v140
  v_add_f32 v156, v156, v172
  v_add_f32 v124, v124, v156
  v_add_f32 v125, v125, v141
  v_add_f32 v157, v157, v173
  v_add_f32 v125, v125, v157
  v_cvt_pk_bf16_f32 v124, v124, v125
  ds_write_b32 v46, v124 offset:1792
  s_waitcnt lgkmcnt(0)
  s_barrier
  v_lshrrev_b32 v46, 4, v1
  v_and_b32 v47, 1, v46
  v_lshlrev_b32 v47, 1, v47
  v_lshrrev_b32 v46, 1, v46
  v_add_u32 v46, v46, v47
  v_lshlrev_b32 v46, 10, v46
  v_and_b32 v47, 15, v1
  v_lshl_add_u32 v46, v47, 4, v46
  s_lshl_b32 s83, s75, 3
  s_add_u32 s83, s83, s73
  s_lshl_b32 s83, s83, 2
  s_add_u32 s83, s83, s72
  s_lshl_b32 s84, s83, 12
  s_add_u32 s84, s84, 1048576
  v_add_u32 v88, s84, v3
  s_lshl_b32 s83, s83, 14
  s_lshl_b32 s84, s81, 8
  s_add_u32 s83, s83, s84
  v_add_u32 v57, s83, v46
  v_add_u32 v58, 0x1000, v57
  v_add_u32 v59, 0x2000, v57
  v_add_u32 v60, 0x3000, v57
  global_load_dwordx4 v[200:203], v57, s[24:25] nt
  global_load_dwordx4 v[204:207], v58, s[24:25] nt
  global_load_dwordx4 v[208:211], v59, s[24:25] nt
  global_load_dwordx4 v[212:215], v60, s[24:25] nt
  v_and_b32 v46, 15, v1
  v_and_b32 v47, 1, v1
  v_cmp_eq_u32 vcc, 1, v47
  v_mov_b32 v48, 0xffff
  v_mov_b32 v49, 0xffff0000
  v_cndmask_b32 v48, v48, v49, vcc
  v_lshrrev_b32 v47, 1, v46
  v_cmp_eq_u32 vcc, 0, v47
  s_nop 1
  v_cndmask_b32 v216, 0, v48, vcc
  v_cmp_eq_u32 vcc, 1, v47
  s_nop 1
  v_cndmask_b32 v217, 0, v48, vcc
  v_cmp_eq_u32 vcc, 2, v47
  s_nop 1
  v_cndmask_b32 v218, 0, v48, vcc
  v_cmp_eq_u32 vcc, 3, v47
  s_nop 1
  v_cndmask_b32 v219, 0, v48, vcc
  s_lshl_b32 s83, s72, 9
  v_lshl_add_u32 v46, v46, 5, s83
  v_bfe_u32 v47, v1, 4, 1
  v_lshl_add_u32 v87, v47, 4, v46
  v_mov_b32 v66, 0
  global_load_ushort v100, v66, s[34:35]
  v_mov_b32 v40, 0
  v_mov_b32 v41, 0
  s_mov_b32 s83, 0xbdd2d3e8
  v_mov_b32 v51, 0xc0135761
  v_lshlrev_b32 v52, 3, v1
  s_mov_b32 s84, 0
L_bloop:
  global_load_dwordx2 v[104:105], v52, s[28:29]
  global_load_dwordx2 v[106:107], v52, s[30:31]
  global_load_dwordx2 v[108:109], v52, s[32:33]
  v_add_u32 v52, 512, v52
  s_waitcnt vmcnt(0)
  v_lshlrev_b32 v42, 16, v104
  v_lshlrev_b32 v43, 16, v106
  v_lshlrev_b32 v44, 16, v108
  v_mul_f32 v46, v232, v42
  v_mul_f32 v47, v233, v42
  v_cvt_pk_bf16_f32 v47, v46, v47
  v_lshlrev_b32 v46, 16, v47
  v_and_b32 v47, 0xffff0000, v47
  v_add_f32 v46, v46, v43
  v_add_f32 v47, v47, v43
  v_cvt_pk_bf16_f32 v47, v46, v47
  v_lshlrev_b32 v46, 16, v47
  v_and_b32 v47, 0xffff0000, v47
  v_mul_f32 v48, v46, v46
  v_mul_f32 v49, v47, v47
  v_fma_f32 v48, v48, s83, v51
  v_fma_f32 v49, v49, s83, v51
  v_mul_f32 v48, v48, v46
  v_mul_f32 v49, v49, v47
  v_exp_f32 v48, v48
  v_exp_f32 v49, v49
  s_nop 0
  v_add_f32 v48, 1.0, v48
  v_add_f32 v49, 1.0, v49
  v_rcp_f32 v48, v48
  v_rcp_f32 v49, v49
  s_nop 0
  v_mul_f32 v48, v48, v46
  v_mul_f32 v49, v49, v47
  v_cvt_pk_bf16_f32 v49, v48, v49
  v_lshlrev_b32 v48, 16, v49
  v_and_b32 v49, 0xffff0000, v49
  v_fmac_f32 v40, v48, v44
  v_fmac_f32 v41, v49, v44
  v_and_b32 v42, 0xffff0000, v104
  v_and_b32 v43, 0xffff0000, v106
  v_and_b32 v44, 0xffff0000, v108
  v_mul_f32 v46, v232, v42
  v_mul_f32 v47, v233, v42
  v_cvt_pk_bf16_f32 v47, v46, v47
  v_lshlrev_b32 v46, 16, v47
  v_and_b32 v47, 0xffff0000, v47
  v_add_f32 v46, v46, v43
  v_add_f32 v47, v47, v43
  v_cvt_pk_bf16_f32 v47, v46, v47
  v_lshlrev_b32 v46, 16, v47
  v_and_b32 v47, 0xffff0000, v47
  v_mul_f32 v48, v46, v46
  v_mul_f32 v49, v47, v47
  v_fma_f32 v48, v48, s83, v51
  v_fma_f32 v49, v49, s83, v51
  v_mul_f32 v48, v48, v46
  v_mul_f32 v49, v49, v47
  v_exp_f32 v48, v48
  v_exp_f32 v49, v49
  s_nop 0
  v_add_f32 v48, 1.0, v48
  v_add_f32 v49, 1.0, v49
  v_rcp_f32 v48, v48
  v_rcp_f32 v49, v49
  s_nop 0
  v_mul_f32 v48, v48, v46
  v_mul_f32 v49, v49, v47
  v_cvt_pk_bf16_f32 v49, v48, v49
  v_lshlrev_b32 v48, 16, v49
  v_and_b32 v49, 0xffff0000, v49
  v_fmac_f32 v40, v48, v44
  v_fmac_f32 v41, v49, v44
  v_lshlrev_b32 v42, 16, v105
  v_lshlrev_b32 v43, 16, v107
  v_lshlrev_b32 v44, 16, v109
  v_mul_f32 v46, v232, v42
  v_mul_f32 v47, v233, v42
  v_cvt_pk_bf16_f32 v47, v46, v47
  v_lshlrev_b32 v46, 16, v47
  v_and_b32 v47, 0xffff0000, v47
  v_add_f32 v46, v46, v43
  v_add_f32 v47, v47, v43
  v_cvt_pk_bf16_f32 v47, v46, v47
  v_lshlrev_b32 v46, 16, v47
  v_and_b32 v47, 0xffff0000, v47
  v_mul_f32 v48, v46, v46
  v_mul_f32 v49, v47, v47
  v_fma_f32 v48, v48, s83, v51
  v_fma_f32 v49, v49, s83, v51
  v_mul_f32 v48, v48, v46
  v_mul_f32 v49, v49, v47
  v_exp_f32 v48, v48
  v_exp_f32 v49, v49
  s_nop 0
  v_add_f32 v48, 1.0, v48
  v_add_f32 v49, 1.0, v49
  v_rcp_f32 v48, v48
  v_rcp_f32 v49, v49
  s_nop 0
  v_mul_f32 v48, v48, v46
  v_mul_f32 v49, v49, v47
  v_cvt_pk_bf16_f32 v49, v48, v49
  v_lshlrev_b32 v48, 16, v49
  v_and_b32 v49, 0xffff0000, v49
  v_fmac_f32 v40, v48, v44
  v_fmac_f32 v41, v49, v44
  v_and_b32 v42, 0xffff0000, v105
  v_and_b32 v43, 0xffff0000, v107
  v_and_b32 v44, 0xffff0000, v109
  v_mul_f32 v46, v232, v42
  v_mul_f32 v47, v233, v42
  v_cvt_pk_bf16_f32 v47, v46, v47
  v_lshlrev_b32 v46, 16, v47
  v_and_b32 v47, 0xffff0000, v47
  v_add_f32 v46, v46, v43
  v_add_f32 v47, v47, v43
  v_cvt_pk_bf16_f32 v47, v46, v47
  v_lshlrev_b32 v46, 16, v47
  v_and_b32 v47, 0xffff0000, v47
  v_mul_f32 v48, v46, v46
  v_mul_f32 v49, v47, v47
  v_fma_f32 v48, v48, s83, v51
  v_fma_f32 v49, v49, s83, v51
  v_mul_f32 v48, v48, v46
  v_mul_f32 v49, v49, v47
  v_exp_f32 v48, v48
  v_exp_f32 v49, v49
  s_nop 0
  v_add_f32 v48, 1.0, v48
  v_add_f32 v49, 1.0, v49
  v_rcp_f32 v48, v48
  v_rcp_f32 v49, v49
  s_nop 0
  v_mul_f32 v48, v48, v46
  v_mul_f32 v49, v49, v47
  v_cvt_pk_bf16_f32 v49, v48, v49
  v_lshlrev_b32 v48, 16, v49
  v_and_b32 v49, 0xffff0000, v49
  v_fmac_f32 v40, v48, v44
  v_fmac_f32 v41, v49, v44
  s_add_u32 s84, s84, 1
  s_cmp_lt_u32 s84, 7
  s_cbranch_scc1 L_bloop
  s_nop 1
  v_add_f32_dpp v40, v40, v40 quad_perm:[1,0,3,2] row_mask:0xf bank_mask:0xf
  s_nop 1
  v_add_f32_dpp v40, v40, v40 quad_perm:[2,3,0,1] row_mask:0xf bank_mask:0xf
  s_nop 1
  v_add_f32_dpp v40, v40, v40 row_half_mirror row_mask:0xf bank_mask:0xf
  s_nop 1
  v_add_f32_dpp v40, v40, v40 row_mirror row_mask:0xf bank_mask:0xf
  v_mov_b32 v46, v40
  s_nop 1
  v_permlane16_swap_b32 v40, v46
  s_nop 0
  v_add_f32 v40, v40, v46
  v_mov_b32 v46, v40
  s_nop 1
  v_permlane32_swap_b32 v40, v46
  s_nop 0
  v_add_f32 v40, v40, v46
  s_nop 1
  v_add_f32_dpp v41, v41, v41 quad_perm:[1,0,3,2] row_mask:0xf bank_mask:0xf
  s_nop 1
  v_add_f32_dpp v41, v41, v41 quad_perm:[2,3,0,1] row_mask:0xf bank_mask:0xf
  s_nop 1
  v_add_f32_dpp v41, v41, v41 row_half_mirror row_mask:0xf bank_mask:0xf
  s_nop 1
  v_add_f32_dpp v41, v41, v41 row_mirror row_mask:0xf bank_mask:0xf
  v_mov_b32 v46, v41
  s_nop 1
  v_permlane16_swap_b32 v41, v46
  s_nop 0
  v_add_f32 v41, v41, v46
  v_mov_b32 v46, v41
  s_nop 1
  v_permlane32_swap_b32 v41, v46
  s_nop 0
  v_add_f32 v41, v41, v46
  v_lshlrev_b32 v48, 16, v100
  v_cvt_pk_bf16_f32 v41, v40, v41
  v_lshlrev_b32 v40, 16, v41
  v_and_b32 v41, 0xffff0000, v41
  v_add_f32 v40, v40, v48
  v_add_f32 v41, v41, v48
  v_cvt_pk_bf16_f32 v41, v40, v41
  v_lshlrev_b32 v40, 16, v41
  v_and_b32 v41, 0xffff0000, v41
  v_mul_f32 v48, s98, v40
  v_mul_f32 v49, s98, v41
  v_exp_f32 v48, -v48
  v_exp_f32 v49, -v49
  s_nop 0
  v_add_f32 v48, 1.0, v48
  v_add_f32 v49, 1.0, v49
  v_rcp_f32 v48, v48
  v_rcp_f32 v49, v49
  s_nop 0
  v_mul_f32 v232, v40, v48
  v_mul_f32 v233, v41, v49
  v_cvt_pk_bf16_f32 v233, v232, v233
  v_lshlrev_b32 v232, 16, v233
  v_and_b32 v233, 0xffff0000, v233
  s_lshl_b32 s82, s75, 2
  s_add_u32 s82, s82, s72
  s_lshl_b32 s83, s82, 15
  s_lshl_b32 s84, s76, 7
  s_add_u32 s83, s83, s84
  s_add_u32 s83, s83, 1048576
  v_lshrrev_b32 v46, 3, v1
  v_lshlrev_b32 v46, 12, v46
  v_and_b32 v47, 7, v1
  v_lshl_add_u32 v46, v47, 4, v46
  v_add_u32 v80, s83, v46
  s_lshl_b32 s83, s72, 11
  v_lshl_add_u32 v81, v1, 5, s83
  v_bfe_u32 v47, v1, 2, 2
  s_lshl_b32 s83, s72, 3
  v_lshl_add_u32 v82, v47, 5, s83
  s_lshl_b32 s83, s72, 5
  v_mov_b32 v83, s83
  s_lshl_b32 s83, s72, 9
  v_lshl_add_u32 v84, v1, 3, s83
  v_and_b32 v46, 1, v1
  v_lshlrev_b32 v85, 4, v46
  v_and_b32 v86, 2, v1
  s_lshl_b32 s84, s75, 3
  s_add_u32 s84, s84, s73
  s_lshl_b32 s84, s84, 12
  s_lshl_b32 s83, s81, 10
  s_add_u32 s83, s83, s84
  s_add_u32 s83, s83, 2097152
  v_add_u32 v89, s83, v3
  s_lshl_b32 s83, s90, 3
  s_add_u32 s83, s83, 2097152
  v_lshl_add_u32 v96, v1, 12, s83
  v_lshlrev_b32 v97, 3, v1
  s_lshl_b32 s83, s90, 1
  v_mov_b32 v90, s83
  s_lshl_b32 s83, s88, 16
  s_and_b32 s84, s88, 0xffff0000
  v_mov_b32 v91, s83
  v_mov_b32 v92, s84
  s_mov_b32 s82, 0x05040100
  s_branch L_tail
L_stream:
  v_and_b32 v46, 3, v1
  v_lshlrev_b32 v46, 2, v46
  v_bfe_u32 v47, v1, 2, 2
  v_add_u32 v46, v46, v47
  v_lshlrev_b32 v46, 8, v46
  v_lshrrev_b32 v47, 4, v1
  v_lshl_add_u32 v2, v47, 4, v46
  s_mul_i32 s78, s81, 3
  s_add_u32 s78, s78, s72
  s_sub_u32 s78, s78, 1
  s_lshl_b32 s78, s78, 12
  s_lshl_b32 s83, s75, 24
  s_lshl_b32 s84, s73, 21
  s_add_u32 s78, s78, s84
  s_waitcnt lgkmcnt(0)
  s_add_u32 s44, s18, s83
  s_addc_u32 s45, s19, 0
  s_and_b32 s45, s45, 0xffff
  s_mov_b32 s46, 0x1000000
  s_mov_b32 s47, 0x20000
  s_add_u32 s48, s20, s83
  s_addc_u32 s49, s21, 0
  s_and_b32 s49, s49, 0xffff
  s_mov_b32 s50, 0x1000000
  s_mov_b32 s51, 0x20000
  s_barrier
  buffer_load_dwordx4 a[0:3], v2, s[44:47], s78 offen offset:0 nt
  buffer_load_dwordx4 a[4:7], v2, s[44:47], s78 offen offset:64 nt
  buffer_load_dwordx4 a[8:11], v2, s[44:47], s78 offen offset:128 nt
  buffer_load_dwordx4 a[12:15], v2, s[44:47], s78 offen offset:192 nt
  buffer_load_dwordx4 a[16:19], v3, s[48:51], s78 offen offset:0 nt
  buffer_load_dwordx4 a[20:23], v3, s[48:51], s78 offen offset:1024 nt
  buffer_load_dwordx4 a[24:27], v3, s[48:51], s78 offen offset:2048 nt
  buffer_load_dwordx4 a[28:31], v3, s[48:51], s78 offen offset:3072 nt
  s_add_u32 s78, s78, 49152
  buffer_load_dwordx4 a[32:35], v2, s[44:47], s78 offen offset:0 nt
  buffer_load_dwordx4 a[36:39], v2, s[44:47], s78 offen offset:64 nt
  buffer_load_dwordx4 a[40:43], v2, s[44:47], s78 offen offset:128 nt
  buffer_load_dwordx4 a[44:47], v2, s[44:47], s78 offen offset:192 nt
  buffer_load_dwordx4 a[48:51], v3, s[48:51], s78 offen offset:0 nt
  buffer_load_dwordx4 a[52:55], v3, s[48:51], s78 offen offset:1024 nt
  buffer_load_dwordx4 a[56:59], v3, s[48:51], s78 offen offset:2048 nt
  buffer_load_dwordx4 a[60:63], v3, s[48:51], s78 offen offset:3072 nt
  s_add_u32 s78, s78, 49152
  v_and_b32 v47, 3, v1
  v_mov_b32 v30, 0x0c0c0c0c
  v_mov_b32 v31, 0x0c0c0c0c
  v_mov_b32 v32, 0x0c0c0c0c
  v_mov_b32 v33, 0x0c0c0c0c
  v_cmp_eq_u32 vcc, 0, v47
  v_mov_b32 v48, 0x0c0c0100
  v_mov_b32 v49, 0x0c0c0302
  v_cndmask_b32 v30, v30, v48, vcc
  v_cndmask_b32 v32, v32, v49, vcc
  v_cmp_eq_u32 vcc, 1, v47
  v_mov_b32 v48, 0x01000c0c
  v_mov_b32 v49, 0x03020c0c
  v_cndmask_b32 v30, v30, v48, vcc
  v_cndmask_b32 v32, v32, v49, vcc
  v_cmp_eq_u32 vcc, 2, v47
  v_mov_b32 v48, 0x0c0c0100
  v_mov_b32 v49, 0x0c0c0302
  v_cndmask_b32 v31, v31, v48, vcc
  v_cndmask_b32 v33, v33, v49, vcc
  v_cmp_eq_u32 vcc, 3, v47
  v_mov_b32 v48, 0x01000c0c
  v_mov_b32 v49, 0x03020c0c
  v_cndmask_b32 v31, v31, v48, vcc
  v_cndmask_b32 v33, v33, v49, vcc
  v_mov_b32 v20, 0
  v_mov_b32 v21, 0
  v_mov_b32 v22, 0
  v_mov_b32 v23, 0
  v_mov_b32 v24, 0
  v_mov_b32 v25, 0
  v_mov_b32 v26, 0
  v_mov_b32 v27, 0
  v_mov_b32 v28, 0
  v_mov_b32 v29, 0
  s_mov_b32 s86, 0xff800000
  s_mov_b32 s87, 0xff7fffff
  s_mov_b32 s99, 0x3db504f3
  s_mov_b32 s79, 0
  s_mov_b32 s77, 8
  s_add_u32 s83, s81, s73
  s_and_b32 s83, s83, 3
  s_lshl_b32 s60, s83, 22
  s_add_u32 s60, s60, 1916928
  s_lshl_b32 s84, s75, 2
  s_add_u32 s84, s84, s83
  s_mul_i32 s80, s84, 1280
  s_add_u32 s80, s80, 65536
  s_mov_b32 s56, 0
  s_mov_b32 s57, 0
  s_mov_b32 s58, 0
  s_mov_b32 s59, 0
  v_bfe_u32 v54, v1, 2, 2
  v_lshlrev_b32 v54, 8, v54
  v_lshrrev_b32 v47, 4, v1
  v_lshl_add_u32 v54, v47, 4, v54
  s_waitcnt vmcnt(12)
  buffer_load_dwordx4 a[64:67], v2, s[44:47], s78 offen offset:0 nt
  buffer_load_dwordx4 a[68:71], v2, s[44:47], s78 offen offset:64 nt
  buffer_load_dwordx4 a[72:75], v2, s[44:47], s78 offen offset:128 nt
  buffer_load_dwordx4 a[76:79], v2, s[44:47], s78 offen offset:192 nt
  buffer_load_dwordx4 a[80:83], v3, s[48:51], s78 offen offset:0 nt
  buffer_load_dwordx4 a[84:87], v3, s[48:51], s78 offen offset:1024 nt
  buffer_load_dwordx4 a[88:91], v3, s[48:51], s78 offen offset:2048 nt
  buffer_load_dwordx4 a[92:95], v3, s[48:51], s78 offen offset:3072 nt
  s_add_u32 s78, s78, 49152
  s_waitcnt vmcnt(12)
  buffer_load_dwordx4 a[96:99], v2, s[44:47], s78 offen offset:0 nt
  buffer_load_dwordx4 a[100:103], v2, s[44:47], s78 offen offset:64 nt
  buffer_load_dwordx4 a[104:107], v2, s[44:47], s78 offen offset:128 nt
  buffer_load_dwordx4 a[108:111], v2, s[44:47], s78 offen offset:192 nt
  buffer_load_dwordx4 a[112:115], v3, s[48:51], s78 offen offset:0 nt
  buffer_load_dwordx4 a[116:119], v3, s[48:51], s78 offen offset:1024 nt
  buffer_load_dwordx4 a[120:123], v3, s[48:51], s78 offen offset:2048 nt
  buffer_load_dwordx4 a[124:127], v3, s[48:51], s78 offen offset:3072 nt
  s_add_u32 s78, s78, 49152
  s_lshl_b32 s82, s75, 2
  s_add_u32 s82, s82, s72
  s_lshl_b32 s83, s82, 15
  s_lshl_b32 s84, s76, 7
  s_add_u32 s83, s83, s84
  s_add_u32 s83, s83, 1048576
  v_lshrrev_b32 v46, 3, v1
  v_lshlrev_b32 v46, 12, v46
  v_and_b32 v47, 7, v1
  v_lshl_add_u32 v46, v47, 4, v46
  v_add_u32 v80, s83, v46
  s_lshl_b32 s83, s72, 11
  v_lshl_add_u32 v81, v1, 5, s83
  v_bfe_u32 v47, v1, 2, 2
  s_lshl_b32 s83, s72, 3
  v_lshl_add_u32 v82, v47, 5, s83
  s_lshl_b32 s83, s72, 5
  v_mov_b32 v83, s83
  s_lshl_b32 s83, s72, 9
  v_lshl_add_u32 v84, v1, 3, s83
  v_and_b32 v46, 1, v1
  v_lshlrev_b32 v85, 4, v46
  v_and_b32 v86, 2, v1
  v_lshrrev_b32 v46, 4, v1
  v_and_b32 v47, 1, v46
  v_lshlrev_b32 v47, 1, v47
  v_lshrrev_b32 v46, 1, v46
  v_add_u32 v46, v46, v47
  v_lshlrev_b32 v46, 10, v46
  v_and_b32 v47, 15, v1
  v_lshl_add_u32 v46, v47, 4, v46
  s_lshl_b32 s83, s75, 3
  s_add_u32 s83, s83, s73
  s_lshl_b32 s83, s83, 2
  s_add_u32 s83, s83, s72
  s_lshl_b32 s84, s83, 12
  s_add_u32 s84, s84, 1048576
  v_add_u32 v88, s84, v3
  s_lshl_b32 s83, s83, 14
  s_lshl_b32 s84, s81, 8
  s_add_u32 s83, s83, s84
  v_add_u32 v57, s83, v46
  v_add_u32 v58, 0x1000, v57
  v_add_u32 v59, 0x2000, v57
  v_add_u32 v60, 0x3000, v57
  global_load_dwordx4 v[200:203], v57, s[24:25] nt
  global_load_dwordx4 v[204:207], v58, s[24:25] nt
  global_load_dwordx4 v[208:211], v59, s[24:25] nt
  global_load_dwordx4 v[212:215], v60, s[24:25] nt
  v_and_b32 v46, 15, v1
  v_and_b32 v47, 1, v1
  v_cmp_eq_u32 vcc, 1, v47
  v_mov_b32 v48, 0xffff
  v_mov_b32 v49, 0xffff0000
  v_cndmask_b32 v48, v48, v49, vcc
  v_lshrrev_b32 v47, 1, v46
  v_cmp_eq_u32 vcc, 0, v47
  s_nop 1
  v_cndmask_b32 v216, 0, v48, vcc
  v_cmp_eq_u32 vcc, 1, v47
  s_nop 1
  v_cndmask_b32 v217, 0, v48, vcc
  v_cmp_eq_u32 vcc, 2, v47
  s_nop 1
  v_cndmask_b32 v218, 0, v48, vcc
  v_cmp_eq_u32 vcc, 3, v47
  s_nop 1
  v_cndmask_b32 v219, 0, v48, vcc
  s_lshl_b32 s83, s72, 9
  v_lshl_add_u32 v46, v46, 5, s83
  v_bfe_u32 v47, v1, 4, 1
  v_lshl_add_u32 v87, v47, 4, v46
  s_waitcnt vmcnt(16)
  buffer_load_dwordx4 a[128:131], v2, s[44:47], s78 offen offset:0 nt
  buffer_load_dwordx4 a[132:135], v2, s[44:47], s78 offen offset:64 nt
  buffer_load_dwordx4 a[136:139], v2, s[44:47], s78 offen offset:128 nt
  buffer_load_dwordx4 a[140:143], v2, s[44:47], s78 offen offset:192 nt
  buffer_load_dwordx4 a[144:147], v3, s[48:51], s78 offen offset:0 nt
  buffer_load_dwordx4 a[148:151], v3, s[48:51], s78 offen offset:1024 nt
  buffer_load_dwordx4 a[152:155], v3, s[48:51], s78 offen offset:2048 nt
  buffer_load_dwordx4 a[156:159], v3, s[48:51], s78 offen offset:3072 nt
  s_add_u32 s78, s78, 49152
  s_waitcnt vmcnt(16)
  buffer_load_dwordx4 a[160:163], v2, s[44:47], s78 offen offset:0 nt
  buffer_load_dwordx4 a[164:167], v2, s[44:47], s78 offen offset:64 nt
  buffer_load_dwordx4 a[168:171], v2, s[44:47], s78 offen offset:128 nt
  buffer_load_dwordx4 a[172:175], v2, s[44:47], s78 offen offset:192 nt
  buffer_load_dwordx4 a[176:179], v3, s[48:51], s78 offen offset:0 nt
  buffer_load_dwordx4 a[180:183], v3, s[48:51], s78 offen offset:1024 nt
  buffer_load_dwordx4 a[184:187], v3, s[48:51], s78 offen offset:2048 nt
  buffer_load_dwordx4 a[188:191], v3, s[48:51], s78 offen offset:3072 nt
  s_add_u32 s78, s78, 49152
  s_waitcnt vmcnt(12)
  buffer_load_dwordx4 a[192:195], v2, s[44:47], s78 offen offset:0 nt
  buffer_load_dwordx4 a[196:199], v2, s[44:47], s78 offen offset:64 nt
  buffer_load_dwordx4 a[200:203], v2, s[44:47], s78 offen offset:128 nt
  buffer_load_dwordx4 a[204:207], v2, s[44:47], s78 offen offset:192 nt
  buffer_load_dwordx4 a[208:211], v3, s[48:51], s78 offen offset:0 nt
  buffer_load_dwordx4 a[212:215], v3, s[48:51], s78 offen offset:1024 nt
  buffer_load_dwordx4 a[216:219], v3, s[48:51], s78 offen offset:2048 nt
  buffer_load_dwordx4 a[220:223], v3, s[48:51], s78 offen offset:3072 nt
  s_add_u32 s78, s78, 49152
  s_waitcnt vmcnt(12)
  buffer_load_dwordx4 a[224:227], v2, s[44:47], s78 offen offset:0 nt
  buffer_load_dwordx4 a[228:231], v2, s[44:47], s78 offen offset:64 nt
  buffer_load_dwordx4 a[232:235], v2, s[44:47], s78 offen offset:128 nt
  buffer_load_dwordx4 a[236:239], v2, s[44:47], s78 offen offset:192 nt
  buffer_load_dwordx4 a[240:243], v3, s[48:51], s78 offen offset:0 nt
  buffer_load_dwordx4 a[244:247], v3, s[48:51], s78 offen offset:1024 nt
  buffer_load_dwordx4 a[248:251], v3, s[48:51], s78 offen offset:2048 nt
  buffer_load_dwordx4 a[252:255], v3, s[48:51], s78 offen offset:3072 nt
  s_add_u32 s78, s78, 49152
  s_barrier
  ds_read_b128 v[4:7], v54 offset:1024
  ds_read_b128 v[8:11], v54 offset:1088
  ds_read_b128 v[12:15], v54 offset:1152
  ds_read_b128 v[16:19], v54 offset:1216
  v_mov_b32 v46, 0
  ds_read_b64 v[48:49], v46 offset:2176
  s_waitcnt lgkmcnt(0)
  v_readfirstlane_b32 s42, v48
  v_readfirstlane_b32 s43, v49
  s_and_b32 s61, s42, 0xffff0000
  v_mfma_f32_16x16x32_bf16 v[34:37], a[0:3], v[4:7], 0
  v_mfma_f32_16x16x32_bf16 v[34:37], a[4:7], v[8:11], v[34:37]
  v_mfma_f32_16x16x32_bf16 v[34:37], a[8:11], v[12:15], v[34:37]
  v_mfma_f32_16x16x32_bf16 v[34:37], a[12:15], v[16:19], v[34:37]
  s_nop 7
  v_cvt_pk_bf16_f32 v46, v34, v35
  v_cvt_pk_bf16_f32 v47, v36, v37
  v_lshlrev_b32 v48, 16, v46
  v_and_b32 v49, 0xffff0000, v46
  v_lshlrev_b32 v50, 16, v47
  v_and_b32 v51, 0xffff0000, v47
  v_mul_f32 v48, s99, v48
  v_mul_f32 v49, s99, v49
  v_mul_f32 v50, s99, v50
  v_mul_f32 v51, s99, v51
  v_cvt_pk_bf16_f32 v46, v48, v49
  v_cvt_pk_bf16_f32 v47, v50, v51
  v_lshlrev_b32 v48, 16, v46
  v_and_b32 v49, 0xffff0000, v46
  v_lshlrev_b32 v50, 16, v47
  v_and_b32 v51, 0xffff0000, v47
  v_fma_f32 v48, v48, s98, v28
  v_fma_f32 v49, v49, s98, v28
  v_fma_f32 v50, v50, s98, v28
  v_fma_f32 v51, v51, s98, v28
  v_max3_f32 v52, v48, v49, v50
  v_max_f32 v52, v52, v51
  v_cmp_lt_f32 vcc, s86, v52
  s_cbranch_vccz L_back0
  s_call_b64 s[92:93], L_rare
L_back0:
  v_exp_f32 v48, v48
  v_exp_f32 v49, v49
  v_exp_f32 v50, v50
  v_exp_f32 v51, v51
  s_nop 0
  v_cvt_pk_bf16_f32 v46, v48, v49
  v_cvt_pk_bf16_f32 v47, v50, v51
  v_add_f32 v48, v48, v49
  v_add_f32 v50, v50, v51
  v_perm_b32 v38, v46, v46, v30
  v_perm_b32 v39, v46, v46, v31
  v_perm_b32 v40, v46, v46, v32
  v_perm_b32 v41, v46, v46, v33
  v_perm_b32 v42, v47, v47, v30
  v_perm_b32 v43, v47, v47, v31
  v_perm_b32 v44, v47, v47, v32
  v_perm_b32 v45, v47, v47, v33
  v_add_f32 v48, v48, v50
  v_add_f32 v29, v29, v48
  v_mfma_f32_16x16x16_bf16 v[20:23], v[38:39], a[16:17], v[20:23]
  v_mfma_f32_16x16x16_bf16 v[24:27], v[38:39], a[18:19], v[24:27]
  v_mfma_f32_16x16x16_bf16 v[20:23], v[40:41], a[20:21], v[20:23]
  v_mfma_f32_16x16x16_bf16 v[24:27], v[40:41], a[22:23], v[24:27]
  v_mfma_f32_16x16x16_bf16 v[20:23], v[42:43], a[24:25], v[20:23]
  v_mfma_f32_16x16x16_bf16 v[24:27], v[42:43], a[26:27], v[24:27]
  v_mfma_f32_16x16x16_bf16 v[20:23], v[44:45], a[28:29], v[20:23]
  v_mfma_f32_16x16x16_bf16 v[24:27], v[44:45], a[30:31], v[24:27]
  s_cmp_lt_u32 s77, 39
  s_cbranch_scc1 L_st0
  s_waitcnt lgkmcnt(1)
  s_cmp_lg_u32 s56, 1
  s_cbranch_scc1 L_tk0
  s_waitcnt lgkmcnt(0)
L_tk0:
  s_and_b32 s83, s56, 1
  s_lshl_b32 s83, s83, 21
  s_and_b32 s78, s56, 0xfffe
  s_lshl_b32 s78, s78, 11
  s_add_u32 s78, s78, s83
  s_add_u32 s78, s78, s60
  s_cmp_ge_u32 s56, 65624
  s_cselect_b32 s79, 0x1000000, s79
  s_max_u32 s78, s78, s79
L_st0:
  s_mov_b32 s52, s78
  s_add_u32 s78, s78, 49152
  s_add_u32 s77, s77, 1
  s_cmp_lg_u32 s79, 0
  s_cbranch_scc1 L_nq0
  s_cmp_lt_u32 s77, 38
  s_cbranch_scc1 L_nq0
  s_mov_b32 s58, 1
  s_atomic_add s58, s[40:41], s80 glc
L_nq0:
  buffer_load_dwordx4 a[0:3], v2, s[44:47], s52 offen offset:0 nt
  buffer_load_dwordx4 a[4:7], v2, s[44:47], s52 offen offset:64 nt
  buffer_load_dwordx4 a[8:11], v2, s[44:47], s52 offen offset:128 nt
  buffer_load_dwordx4 a[12:15], v2, s[44:47], s52 offen offset:192 nt
  buffer_load_dwordx4 a[16:19], v3, s[48:51], s52 offen offset:0 nt
  buffer_load_dwordx4 a[20:23], v3, s[48:51], s52 offen offset:1024 nt
  buffer_load_dwordx4 a[24:27], v3, s[48:51], s52 offen offset:2048 nt
  buffer_load_dwordx4 a[28:31], v3, s[48:51], s52 offen offset:3072 nt
  v_mfma_f32_16x16x32_bf16 v[34:37], a[32:35], v[4:7], 0
  v_mfma_f32_16x16x32_bf16 v[34:37], a[36:39], v[8:11], v[34:37]
  v_mfma_f32_16x16x32_bf16 v[34:37], a[40:43], v[12:15], v[34:37]
  v_mfma_f32_16x16x32_bf16 v[34:37], a[44:47], v[16:19], v[34:37]
  s_nop 7
  v_cvt_pk_bf16_f32 v46, v34, v35
  v_cvt_pk_bf16_f32 v47, v36, v37
  v_lshlrev_b32 v48, 16, v46
  v_and_b32 v49, 0xffff0000, v46
  v_lshlrev_b32 v50, 16, v47
  v_and_b32 v51, 0xffff0000, v47
  v_mul_f32 v48, s99, v48
  v_mul_f32 v49, s99, v49
  v_mul_f32 v50, s99, v50
  v_mul_f32 v51, s99, v51
  v_cvt_pk_bf16_f32 v46, v48, v49
  v_cvt_pk_bf16_f32 v47, v50, v51
  v_lshlrev_b32 v48, 16, v46
  v_and_b32 v49, 0xffff0000, v46
  v_lshlrev_b32 v50, 16, v47
  v_and_b32 v51, 0xffff0000, v47
  v_fma_f32 v48, v48, s98, v28
  v_fma_f32 v49, v49, s98, v28
  v_fma_f32 v50, v50, s98, v28
  v_fma_f32 v51, v51, s98, v28
  v_max3_f32 v52, v48, v49, v50
  v_max_f32 v52, v52, v51
  v_cmp_lt_f32 vcc, s86, v52
  s_cbranch_vccz L_back1
  s_call_b64 s[92:93], L_rare
L_back1:
  v_exp_f32 v48, v48
  v_exp_f32 v49, v49
  v_exp_f32 v50, v50
  v_exp_f32 v51, v51
  s_nop 0
  v_cvt_pk_bf16_f32 v46, v48, v49
  v_cvt_pk_bf16_f32 v47, v50, v51
  v_add_f32 v48, v48, v49
  v_add_f32 v50, v50, v51
  v_perm_b32 v38, v46, v46, v30
  v_perm_b32 v39, v46, v46, v31
  v_perm_b32 v40, v46, v46, v32
  v_perm_b32 v41, v46, v46, v33
  v_perm_b32 v42, v47, v47, v30
  v_perm_b32 v43, v47, v47, v31
  v_perm_b32 v44, v47, v47, v32
  v_perm_b32 v45, v47, v47, v33
  v_add_f32 v48, v48, v50
  v_add_f32 v29, v29, v48
  v_mfma_f32_16x16x16_bf16 v[20:23], v[38:39], a[48:49], v[20:23]
  v_mfma_f32_16x16x16_bf16 v[24:27], v[38:39], a[50:51], v[24:27]
  v_mfma_f32_16x16x16_bf16 v[20:23], v[40:41], a[52:53], v[20:23]
  v_mfma_f32_16x16x16_bf16 v[24:27], v[40:41], a[54:55], v[24:27]
  v_mfma_f32_16x16x16_bf16 v[20:23], v[42:43], a[56:57], v[20:23]
  v_mfma_f32_16x16x16_bf16 v[24:27], v[42:43], a[58:59], v[24:27]
  v_mfma_f32_16x16x16_bf16 v[20:23], v[44:45], a[60:61], v[20:23]
  v_mfma_f32_16x16x16_bf16 v[24:27], v[44:45], a[62:63], v[24:27]
  s_cmp_lt_u32 s77, 39
  s_cbranch_scc1 L_st1
  s_waitcnt lgkmcnt(1)
  s_cmp_lg_u32 s57, 1
  s_cbranch_scc1 L_tk1
  s_waitcnt lgkmcnt(0)
L_tk1:
  s_and_b32 s83, s57, 1
  s_lshl_b32 s83, s83, 21
  s_and_b32 s78, s57, 0xfffe
  s_lshl_b32 s78, s78, 11
  s_add_u32 s78, s78, s83
  s_add_u32 s78, s78, s60
  s_cmp_ge_u32 s57, 65624
  s_cselect_b32 s79, 0x1000000, s79
  s_max_u32 s78, s78, s79
L_st1:
  s_mov_b32 s53, s78
  s_add_u32 s78, s78, 49152
  s_add_u32 s77, s77, 1
  s_cmp_lg_u32 s79, 0
  s_cbranch_scc1 L_nq1
  s_cmp_lt_u32 s77, 38
  s_cbranch_scc1 L_nq1
  s_mov_b32 s59, 1
  s_atomic_add s59, s[40:41], s80 glc
L_nq1:
  buffer_load_dwordx4 a[32:35], v2, s[44:47], s53 offen offset:0 nt
  buffer_load_dwordx4 a[36:39], v2, s[44:47], s53 offen offset:64 nt
  buffer_load_dwordx4 a[40:43], v2, s[44:47], s53 offen offset:128 nt
  buffer_load_dwordx4 a[44:47], v2, s[44:47], s53 offen offset:192 nt
  buffer_load_dwordx4 a[48:51], v3, s[48:51], s53 offen offset:0 nt
  buffer_load_dwordx4 a[52:55], v3, s[48:51], s53 offen offset:1024 nt
  buffer_load_dwordx4 a[56:59], v3, s[48:51], s53 offen offset:2048 nt
  buffer_load_dwordx4 a[60:63], v3, s[48:51], s53 offen offset:3072 nt
  v_mfma_f32_16x16x32_bf16 v[34:37], a[64:67], v[4:7], 0
  v_mfma_f32_16x16x32_bf16 v[34:37], a[68:71], v[8:11], v[34:37]
  v_mfma_f32_16x16x32_bf16 v[34:37], a[72:75], v[12:15], v[34:37]
  v_mfma_f32_16x16x32_bf16 v[34:37], a[76:79], v[16:19], v[34:37]
  s_nop 7
  v_cvt_pk_bf16_f32 v46, v34, v35
  v_cvt_pk_bf16_f32 v47, v36, v37
  v_lshlrev_b32 v48, 16, v46
  v_and_b32 v49, 0xffff0000, v46
  v_lshlrev_b32 v50, 16, v47
  v_and_b32 v51, 0xffff0000, v47
  v_mul_f32 v48, s99, v48
  v_mul_f32 v49, s99, v49
  v_mul_f32 v50, s99, v50
  v_mul_f32 v51, s99, v51
  v_cvt_pk_bf16_f32 v46, v48, v49
  v_cvt_pk_bf16_f32 v47, v50, v51
  v_lshlrev_b32 v48, 16, v46
  v_and_b32 v49, 0xffff0000, v46
  v_lshlrev_b32 v50, 16, v47
  v_and_b32 v51, 0xffff0000, v47
  v_fma_f32 v48, v48, s98, v28
  v_fma_f32 v49, v49, s98, v28
  v_fma_f32 v50, v50, s98, v28
  v_fma_f32 v51, v51, s98, v28
  v_max3_f32 v52, v48, v49, v50
  v_max_f32 v52, v52, v51
  v_cmp_lt_f32 vcc, s86, v52
  s_cbranch_vccz L_back2
  s_call_b64 s[92:93], L_rare
L_back2:
  v_exp_f32 v48, v48
  v_exp_f32 v49, v49
  v_exp_f32 v50, v50
  v_exp_f32 v51, v51
  s_nop 0
  v_cvt_pk_bf16_f32 v46, v48, v49
  v_cvt_pk_bf16_f32 v47, v50, v51
  v_add_f32 v48, v48, v49
  v_add_f32 v50, v50, v51
  v_perm_b32 v38, v46, v46, v30
  v_perm_b32 v39, v46, v46, v31
  v_perm_b32 v40, v46, v46, v32
  v_perm_b32 v41, v46, v46, v33
  v_perm_b32 v42, v47, v47, v30
  v_perm_b32 v43, v47, v47, v31
  v_perm_b32 v44, v47, v47, v32
  v_perm_b32 v45, v47, v47, v33
  v_add_f32 v48, v48, v50
  v_add_f32 v29, v29, v48
  v_mfma_f32_16x16x16_bf16 v[20:23], v[38:39], a[80:81], v[20:23]
  v_mfma_f32_16x16x16_bf16 v[24:27], v[38:39], a[82:83], v[24:27]
  v_mfma_f32_16x16x16_bf16 v[20:23], v[40:41], a[84:85], v[20:23]
  v_mfma_f32_16x16x16_bf16 v[24:27], v[40:41], a[86:87], v[24:27]
  v_mfma_f32_16x16x16_bf16 v[20:23], v[42:43], a[88:89], v[20:23]
  v_mfma_f32_16x16x16_bf16 v[24:27], v[42:43], a[90:91], v[24:27]
  v_mfma_f32_16x16x16_bf16 v[20:23], v[44:45], a[92:93], v[20:23]
  v_mfma_f32_16x16x16_bf16 v[24:27], v[44:45], a[94:95], v[24:27]
  v_mfma_f32_16x16x32_bf16 v[34:37], a[96:99], v[4:7], 0
  v_mfma_f32_16x16x32_bf16 v[34:37], a[100:103], v[8:11], v[34:37]
  v_mfma_f32_16x16x32_bf16 v[34:37], a[104:107], v[12:15], v[34:37]
  v_mfma_f32_16x16x32_bf16 v[34:37], a[108:111], v[16:19], v[34:37]
  s_nop 7
  v_cvt_pk_bf16_f32 v46, v34, v35
  v_cvt_pk_bf16_f32 v47, v36, v37
  v_lshlrev_b32 v48, 16, v46
  v_and_b32 v49, 0xffff0000, v46
  v_lshlrev_b32 v50, 16, v47
  v_and_b32 v51, 0xffff0000, v47
  v_mul_f32 v48, s99, v48
  v_mul_f32 v49, s99, v49
  v_mul_f32 v50, s99, v50
  v_mul_f32 v51, s99, v51
  v_cvt_pk_bf16_f32 v46, v48, v49
  v_cvt_pk_bf16_f32 v47, v50, v51
  v_lshlrev_b32 v48, 16, v46
  v_and_b32 v49, 0xffff0000, v46
  v_lshlrev_b32 v50, 16, v47
  v_and_b32 v51, 0xffff0000, v47
  v_fma_f32 v48, v48, s98, v28
  v_fma_f32 v49, v49, s98, v28
  v_fma_f32 v50, v50, s98, v28
  v_fma_f32 v51, v51, s98, v28
  v_max3_f32 v52, v48, v49, v50
  v_max_f32 v52, v52, v51
  v_cmp_lt_f32 vcc, s86, v52
  s_cbranch_vccz L_back3
  s_call_b64 s[92:93], L_rare
L_back3:
  v_exp_f32 v48, v48
  v_exp_f32 v49, v49
  v_exp_f32 v50, v50
  v_exp_f32 v51, v51
  s_nop 0
  v_cvt_pk_bf16_f32 v46, v48, v49
  v_cvt_pk_bf16_f32 v47, v50, v51
  v_add_f32 v48, v48, v49
  v_add_f32 v50, v50, v51
  v_perm_b32 v38, v46, v46, v30
  v_perm_b32 v39, v46, v46, v31
  v_perm_b32 v40, v46, v46, v32
  v_perm_b32 v41, v46, v46, v33
  v_perm_b32 v42, v47, v47, v30
  v_perm_b32 v43, v47, v47, v31
  v_perm_b32 v44, v47, v47, v32
  v_perm_b32 v45, v47, v47, v33
  v_add_f32 v48, v48, v50
  v_add_f32 v29, v29, v48
  v_mfma_f32_16x16x16_bf16 v[20:23], v[38:39], a[112:113], v[20:23]
  v_mfma_f32_16x16x16_bf16 v[24:27], v[38:39], a[114:115], v[24:27]
  v_mfma_f32_16x16x16_bf16 v[20:23], v[40:41], a[116:117], v[20:23]
  v_mfma_f32_16x16x16_bf16 v[24:27], v[40:41], a[118:119], v[24:27]
  v_mfma_f32_16x16x16_bf16 v[20:23], v[42:43], a[120:121], v[20:23]
  v_mfma_f32_16x16x16_bf16 v[24:27], v[42:43], a[122:123], v[24:27]
  v_mfma_f32_16x16x16_bf16 v[20:23], v[44:45], a[124:125], v[20:23]
  v_mfma_f32_16x16x16_bf16 v[24:27], v[44:45], a[126:127], v[24:27]
  v_mfma_f32_16x16x32_bf16 v[34:37], a[128:131], v[4:7], 0
  v_mfma_f32_16x16x32_bf16 v[34:37], a[132:135], v[8:11], v[34:37]
  v_mfma_f32_16x16x32_bf16 v[34:37], a[136:139], v[12:15], v[34:37]
  v_mfma_f32_16x16x32_bf16 v[34:37], a[140:143], v[16:19], v[34:37]
  s_nop 7
  v_cvt_pk_bf16_f32 v46, v34, v35
  v_cvt_pk_bf16_f32 v47, v36, v37
  v_lshlrev_b32 v48, 16, v46
  v_and_b32 v49, 0xffff0000, v46
  v_lshlrev_b32 v50, 16, v47
  v_and_b32 v51, 0xffff0000, v47
  v_mul_f32 v48, s99, v48
  v_mul_f32 v49, s99, v49
  v_mul_f32 v50, s99, v50
  v_mul_f32 v51, s99, v51
  v_cvt_pk_bf16_f32 v46, v48, v49
  v_cvt_pk_bf16_f32 v47, v50, v51
  v_lshlrev_b32 v48, 16, v46
  v_and_b32 v49, 0xffff0000, v46
  v_lshlrev_b32 v50, 16, v47
  v_and_b32 v51, 0xffff0000, v47
  v_fma_f32 v48, v48, s98, v28
  v_fma_f32 v49, v49, s98, v28
  v_fma_f32 v50, v50, s98, v28
  v_fma_f32 v51, v51, s98, v28
  v_max3_f32 v52, v48, v49, v50
  v_max_f32 v52, v52, v51
  v_cmp_lt_f32 vcc, s86, v52
  s_cbranch_vccz L_back4
  s_call_b64 s[92:93], L_rare
L_back4:
  v_exp_f32 v48, v48
  v_exp_f32 v49, v49
  v_exp_f32 v50, v50
  v_exp_f32 v51, v51
  s_nop 0
  v_cvt_pk_bf16_f32 v46, v48, v49
  v_cvt_pk_bf16_f32 v47, v50, v51
  v_add_f32 v48, v48, v49
  v_add_f32 v50, v50, v51
  v_perm_b32 v38, v46, v46, v30
  v_perm_b32 v39, v46, v46, v31
  v_perm_b32 v40, v46, v46, v32
  v_perm_b32 v41, v46, v46, v33
  v_perm_b32 v42, v47, v47, v30
  v_perm_b32 v43, v47, v47, v31
  v_perm_b32 v44, v47, v47, v32
  v_perm_b32 v45, v47, v47, v33
  v_add_f32 v48, v48, v50
  v_add_f32 v29, v29, v48
  v_mfma_f32_16x16x16_bf16 v[20:23], v[38:39], a[144:145], v[20:23]
  v_mfma_f32_16x16x16_bf16 v[24:27], v[38:39], a[146:147], v[24:27]
  v_mfma_f32_16x16x16_bf16 v[20:23], v[40:41], a[148:149], v[20:23]
  v_mfma_f32_16x16x16_bf16 v[24:27], v[40:41], a[150:151], v[24:27]
  v_mfma_f32_16x16x16_bf16 v[20:23], v[42:43], a[152:153], v[20:23]
  v_mfma_f32_16x16x16_bf16 v[24:27], v[42:43], a[154:155], v[24:27]
  v_mfma_f32_16x16x16_bf16 v[20:23], v[44:45], a[156:157], v[20:23]
  v_mfma_f32_16x16x16_bf16 v[24:27], v[44:45], a[158:159], v[24:27]
  v_mfma_f32_16x16x32_bf16 v[34:37], a[160:163], v[4:7], 0
  v_mfma_f32_16x16x32_bf16 v[34:37], a[164:167], v[8:11], v[34:37]
  v_mfma_f32_16x16x32_bf16 v[34:37], a[168:171], v[12:15], v[34:37]
  v_mfma_f32_16x16x32_bf16 v[34:37], a[172:175], v[16:19], v[34:37]
  s_nop 7
  v_cvt_pk_bf16_f32 v46, v34, v35
  v_cvt_pk_bf16_f32 v47, v36, v37
  v_lshlrev_b32 v48, 16, v46
  v_and_b32 v49, 0xffff0000, v46
  v_lshlrev_b32 v50, 16, v47
  v_and_b32 v51, 0xffff0000, v47
  v_mul_f32 v48, s99, v48
  v_mul_f32 v49, s99, v49
  v_mul_f32 v50, s99, v50
  v_mul_f32 v51, s99, v51
  v_cvt_pk_bf16_f32 v46, v48, v49
  v_cvt_pk_bf16_f32 v47, v50, v51
  v_lshlrev_b32 v48, 16, v46
  v_and_b32 v49, 0xffff0000, v46
  v_lshlrev_b32 v50, 16, v47
  v_and_b32 v51, 0xffff0000, v47
  v_fma_f32 v48, v48, s98, v28
  v_fma_f32 v49, v49, s98, v28
  v_fma_f32 v50, v50, s98, v28
  v_fma_f32 v51, v51, s98, v28
  v_max3_f32 v52, v48, v49, v50
  v_max_f32 v52, v52, v51
  v_cmp_lt_f32 vcc, s86, v52
  s_cbranch_vccz L_back5
  s_call_b64 s[92:93], L_rare
L_back5:
  v_exp_f32 v48, v48
  v_exp_f32 v49, v49
  v_exp_f32 v50, v50
  v_exp_f32 v51, v51
  s_nop 0
  v_cvt_pk_bf16_f32 v46, v48, v49
  v_cvt_pk_bf16_f32 v47, v50, v51
  v_add_f32 v48, v48, v49
  v_add_f32 v50, v50, v51
  v_perm_b32 v38, v46, v46, v30
  v_perm_b32 v39, v46, v46, v31
  v_perm_b32 v40, v46, v46, v32
  v_perm_b32 v41, v46, v46, v33
  v_perm_b32 v42, v47, v47, v30
  v_perm_b32 v43, v47, v47, v31
  v_perm_b32 v44, v47, v47, v32
  v_perm_b32 v45, v47, v47, v33
  v_add_f32 v48, v48, v50
  v_add_f32 v29, v29, v48
  s_waitcnt vmcnt(32)
  v_mfma_f32_16x16x16_bf16 v[20:23], v[38:39], a[176:177], v[20:23]
  v_mfma_f32_16x16x16_bf16 v[24:27], v[38:39], a[178:179], v[24:27]
  v_mfma_f32_16x16x16_bf16 v[20:23], v[40:41], a[180:181], v[20:23]
  v_mfma_f32_16x16x16_bf16 v[24:27], v[40:41], a[182:183], v[24:27]
  v_mfma_f32_16x16x16_bf16 v[20:23], v[42:43], a[184:185], v[20:23]
  v_mfma_f32_16x16x16_bf16 v[24:27], v[42:43], a[186:187], v[24:27]
  v_mfma_f32_16x16x16_bf16 v[20:23], v[44:45], a[188:189], v[20:23]
  v_mfma_f32_16x16x16_bf16 v[24:27], v[44:45], a[190:191], v[24:27]
  s_cmp_lt_u32 s77, 39
  s_cbranch_scc1 L_st2
  s_waitcnt lgkmcnt(1)
  s_cmp_lg_u32 s58, 1
  s_cbranch_scc1 L_tk2
  s_waitcnt lgkmcnt(0)
L_tk2:
  s_and_b32 s83, s58, 1
  s_lshl_b32 s83, s83, 21
  s_and_b32 s78, s58, 0xfffe
  s_lshl_b32 s78, s78, 11
  s_add_u32 s78, s78, s83
  s_add_u32 s78, s78, s60
  s_cmp_ge_u32 s58, 65624
  s_cselect_b32 s79, 0x1000000, s79
  s_max_u32 s78, s78, s79
L_st2:
  s_mov_b32 s54, s78
  s_add_u32 s78, s78, 49152
  s_add_u32 s77, s77, 1
  s_cmp_lg_u32 s79, 0
  s_cbranch_scc1 L_nq2
  s_cmp_lt_u32 s77, 38
  s_cbranch_scc1 L_nq2
  s_mov_b32 s56, 1
  s_atomic_add s56, s[40:41], s80 glc
L_nq2:
  buffer_load_dwordx4 a[64:67], v2, s[44:47], s54 offen offset:0 nt
  buffer_load_dwordx4 a[68:71], v2, s[44:47], s54 offen offset:64 nt
  buffer_load_dwordx4 a[72:75], v2, s[44:47], s54 offen offset:128 nt
  buffer_load_dwordx4 a[76:79], v2, s[44:47], s54 offen offset:192 nt
  buffer_load_dwordx4 a[80:83], v3, s[48:51], s54 offen offset:0 nt
  buffer_load_dwordx4 a[84:87], v3, s[48:51], s54 offen offset:1024 nt
  buffer_load_dwordx4 a[88:91], v3, s[48:51], s54 offen offset:2048 nt
  buffer_load_dwordx4 a[92:95], v3, s[48:51], s54 offen offset:3072 nt
  s_waitcnt vmcnt(36)
  v_mfma_f32_16x16x32_bf16 v[34:37], a[192:195], v[4:7], 0
  v_mfma_f32_16x16x32_bf16 v[34:37], a[196:199], v[8:11], v[34:37]
  v_mfma_f32_16x16x32_bf16 v[34:37], a[200:203], v[12:15], v[34:37]
  v_mfma_f32_16x16x32_bf16 v[34:37], a[204:207], v[16:19], v[34:37]
  s_nop 7
  v_cvt_pk_bf16_f32 v46, v34, v35
  v_cvt_pk_bf16_f32 v47, v36, v37
  v_lshlrev_b32 v48, 16, v46
  v_and_b32 v49, 0xffff0000, v46
  v_lshlrev_b32 v50, 16, v47
  v_and_b32 v51, 0xffff0000, v47
  v_mul_f32 v48, s99, v48
  v_mul_f32 v49, s99, v49
  v_mul_f32 v50, s99, v50
  v_mul_f32 v51, s99, v51
  v_cvt_pk_bf16_f32 v46, v48, v49
  v_cvt_pk_bf16_f32 v47, v50, v51
  v_lshlrev_b32 v48, 16, v46
  v_and_b32 v49, 0xffff0000, v46
  v_lshlrev_b32 v50, 16, v47
  v_and_b32 v51, 0xffff0000, v47
  v_fma_f32 v48, v48, s98, v28
  v_fma_f32 v49, v49, s98, v28
  v_fma_f32 v50, v50, s98, v28
  v_fma_f32 v51, v51, s98, v28
  v_max3_f32 v52, v48, v49, v50
  v_max_f32 v52, v52, v51
  v_cmp_lt_f32 vcc, s86, v52
  s_cbranch_vccz L_back6
  s_call_b64 s[92:93], L_rare
L_back6:
  v_exp_f32 v48, v48
  v_exp_f32 v49, v49
  v_exp_f32 v50, v50
  v_exp_f32 v51, v51
  s_nop 0
  v_cvt_pk_bf16_f32 v46, v48, v49
  v_cvt_pk_bf16_f32 v47, v50, v51
  v_add_f32 v48, v48, v49
  v_add_f32 v50, v50, v51
  v_perm_b32 v38, v46, v46, v30
  v_perm_b32 v39, v46, v46, v31
  v_perm_b32 v40, v46, v46, v32
  v_perm_b32 v41, v46, v46, v33
  v_perm_b32 v42, v47, v47, v30
  v_perm_b32 v43, v47, v47, v31
  v_perm_b32 v44, v47, v47, v32
  v_perm_b32 v45, v47, v47, v33
  v_add_f32 v48, v48, v50
  v_add_f32 v29, v29, v48
  s_waitcnt vmcnt(32)
  v_mfma_f32_16x16x16_bf16 v[20:23], v[38:39], a[208:209], v[20:23]
  v_mfma_f32_16x16x16_bf16 v[24:27], v[38:39], a[210:211], v[24:27]
  v_mfma_f32_16x16x16_bf16 v[20:23], v[40:41], a[212:213], v[20:23]
  v_mfma_f32_16x16x16_bf16 v[24:27], v[40:41], a[214:215], v[24:27]
  v_mfma_f32_16x16x16_bf16 v[20:23], v[42:43], a[216:217], v[20:23]
  v_mfma_f32_16x16x16_bf16 v[24:27], v[42:43], a[218:219], v[24:27]
  v_mfma_f32_16x16x16_bf16 v[20:23], v[44:45], a[220:221], v[20:23]
  v_mfma_f32_16x16x16_bf16 v[24:27], v[44:45], a[222:223], v[24:27]
  s_waitcnt vmcnt(28)
  v_mfma_f32_16x16x32_bf16 v[34:37], a[224:227], v[4:7], 0
  v_mfma_f32_16x16x32_bf16 v[34:37], a[228:231], v[8:11], v[34:37]
  v_mfma_f32_16x16x32_bf16 v[34:37], a[232:235], v[12:15], v[34:37]
  v_mfma_f32_16x16x32_bf16 v[34:37], a[236:239], v[16:19], v[34:37]
  s_nop 7
  v_cvt_pk_bf16_f32 v46, v34, v35
  v_cvt_pk_bf16_f32 v47, v36, v37
  v_lshlrev_b32 v48, 16, v46
  v_and_b32 v49, 0xffff0000, v46
  v_lshlrev_b32 v50, 16, v47
  v_and_b32 v51, 0xffff0000, v47
  v_mul_f32 v48, s99, v48
  v_mul_f32 v49, s99, v49
  v_mul_f32 v50, s99, v50
  v_mul_f32 v51, s99, v51
  v_cvt_pk_bf16_f32 v46, v48, v49
  v_cvt_pk_bf16_f32 v47, v50, v51
  v_lshlrev_b32 v48, 16, v46
  v_and_b32 v49, 0xffff0000, v46
  v_lshlrev_b32 v50, 16, v47
  v_and_b32 v51, 0xffff0000, v47
  v_fma_f32 v48, v48, s98, v28
  v_fma_f32 v49, v49, s98, v28
  v_fma_f32 v50, v50, s98, v28
  v_fma_f32 v51, v51, s98, v28
  v_max3_f32 v52, v48, v49, v50
  v_max_f32 v52, v52, v51
  v_cmp_lt_f32 vcc, s86, v52
  s_cbranch_vccz L_back7
  s_call_b64 s[92:93], L_rare
L_back7:
  v_exp_f32 v48, v48
  v_exp_f32 v49, v49
  v_exp_f32 v50, v50
  v_exp_f32 v51, v51
  s_nop 0
  v_cvt_pk_bf16_f32 v46, v48, v49
  v_cvt_pk_bf16_f32 v47, v50, v51
  v_add_f32 v48, v48, v49
  v_add_f32 v50, v50, v51
  v_perm_b32 v38, v46, v46, v30
  v_perm_b32 v39, v46, v46, v31
  v_perm_b32 v40, v46, v46, v32
  v_perm_b32 v41, v46, v46, v33
  v_perm_b32 v42, v47, v47, v30
  v_perm_b32 v43, v47, v47, v31
  v_perm_b32 v44, v47, v47, v32
  v_perm_b32 v45, v47, v47, v33
  v_add_f32 v48, v48, v50
  v_add_f32 v29, v29, v48
  s_waitcnt vmcnt(24)
  v_mfma_f32_16x16x16_bf16 v[20:23], v[38:39], a[240:241], v[20:23]
  v_mfma_f32_16x16x16_bf16 v[24:27], v[38:39], a[242:243], v[24:27]
  v_mfma_f32_16x16x16_bf16 v[20:23], v[40:41], a[244:245], v[20:23]
  v_mfma_f32_16x16x16_bf16 v[24:27], v[40:41], a[246:247], v[24:27]
  v_mfma_f32_16x16x16_bf16 v[20:23], v[42:43], a[248:249], v[20:23]
  v_mfma_f32_16x16x16_bf16 v[24:27], v[42:43], a[250:251], v[24:27]
  v_mfma_f32_16x16x16_bf16 v[20:23], v[44:45], a[252:253], v[20:23]
  v_mfma_f32_16x16x16_bf16 v[24:27], v[44:45], a[254:255], v[24:27]
  s_waitcnt vmcnt(20)
  v_mfma_f32_16x16x32_bf16 v[34:37], a[0:3], v[4:7], 0
  v_mfma_f32_16x16x32_bf16 v[34:37], a[4:7], v[8:11], v[34:37]
  v_mfma_f32_16x16x32_bf16 v[34:37], a[8:11], v[12:15], v[34:37]
  v_mfma_f32_16x16x32_bf16 v[34:37], a[12:15], v[16:19], v[34:37]
  s_nop 7
  v_cvt_pk_bf16_f32 v46, v34, v35
  v_cvt_pk_bf16_f32 v47, v36, v37
  v_lshlrev_b32 v48, 16, v46
  v_and_b32 v49, 0xffff0000, v46
  v_lshlrev_b32 v50, 16, v47
  v_and_b32 v51, 0xffff0000, v47
  v_mul_f32 v48, s99, v48
  v_mul_f32 v49, s99, v49
  v_mul_f32 v50, s99, v50
  v_mul_f32 v51, s99, v51
  v_cvt_pk_bf16_f32 v46, v48, v49
  v_cvt_pk_bf16_f32 v47, v50, v51
  v_lshlrev_b32 v48, 16, v46
  v_and_b32 v49, 0xffff0000, v46
  v_lshlrev_b32 v50, 16, v47
  v_and_b32 v51, 0xffff0000, v47
  v_fma_f32 v48, v48, s98, v28
  v_fma_f32 v49, v49, s98, v28
  v_fma_f32 v50, v50, s98, v28
  v_fma_f32 v51, v51, s98, v28
  v_max3_f32 v52, v48, v49, v50
  v_max_f32 v52, v52, v51
  v_cmp_lt_f32 vcc, s86, v52
  s_cbranch_vccz L_back8
  s_call_b64 s[92:93], L_rare
L_back8:
  v_exp_f32 v48, v48
  v_exp_f32 v49, v49
  v_exp_f32 v50, v50
  v_exp_f32 v51, v51
  s_nop 0
  v_cvt_pk_bf16_f32 v46, v48, v49
  v_cvt_pk_bf16_f32 v47, v50, v51
  v_add_f32 v48, v48, v49
  v_add_f32 v50, v50, v51
  v_perm_b32 v38, v46, v46, v30
  v_perm_b32 v39, v46, v46, v31
  v_perm_b32 v40, v46, v46, v32
  v_perm_b32 v41, v46, v46, v33
  v_perm_b32 v42, v47, v47, v30
  v_perm_b32 v43, v47, v47, v31
  v_perm_b32 v44, v47, v47, v32
  v_perm_b32 v45, v47, v47, v33
  v_add_f32 v48, v48, v50
  v_add_f32 v29, v29, v48
  s_waitcnt vmcnt(16)
  v_mfma_f32_16x16x16_bf16 v[20:23], v[38:39], a[16:17], v[20:23]
  v_mfma_f32_16x16x16_bf16 v[24:27], v[38:39], a[18:19], v[24:27]
  v_mfma_f32_16x16x16_bf16 v[20:23], v[40:41], a[20:21], v[20:23]
  v_mfma_f32_16x16x16_bf16 v[24:27], v[40:41], a[22:23], v[24:27]
  v_mfma_f32_16x16x16_bf16 v[20:23], v[42:43], a[24:25], v[20:23]
  v_mfma_f32_16x16x16_bf16 v[24:27], v[42:43], a[26:27], v[24:27]
  v_mfma_f32_16x16x16_bf16 v[20:23], v[44:45], a[28:29], v[20:23]
  v_mfma_f32_16x16x16_bf16 v[24:27], v[44:45], a[30:31], v[24:27]
  s_cmp_lt_u32 s77, 39
  s_cbranch_scc1 L_st3
  s_waitcnt lgkmcnt(1)
  s_cmp_lg_u32 s59, 1
  s_cbranch_scc1 L_tk3
  s_waitcnt lgkmcnt(0)
L_tk3:
  s_and_b32 s83, s59, 1
  s_lshl_b32 s83, s83, 21
  s_and_b32 s78, s59, 0xfffe
  s_lshl_b32 s78, s78, 11
  s_add_u32 s78, s78, s83
  s_add_u32 s78, s78, s60
  s_cmp_ge_u32 s59, 65624
  s_cselect_b32 s79, 0x1000000, s79
  s_max_u32 s78, s78, s79
L_st3:
  s_mov_b32 s55, s78
  s_add_u32 s78, s78, 49152
  s_add_u32 s77, s77, 1
  s_cmp_lg_u32 s79, 0
  s_cbranch_scc1 L_nq3
  s_cmp_lt_u32 s77, 38
  s_cbranch_scc1 L_nq3
  s_mov_b32 s57, 1
  s_atomic_add s57, s[40:41], s80 glc
L_nq3:
  buffer_load_dwordx4 a[96:99], v2, s[44:47], s55 offen offset:0 nt
  buffer_load_dwordx4 a[100:103], v2, s[44:47], s55 offen offset:64 nt
  buffer_load_dwordx4 a[104:107], v2, s[44:47], s55 offen offset:128 nt
  buffer_load_dwordx4 a[108:111], v2, s[44:47], s55 offen offset:192 nt
  buffer_load_dwordx4 a[112:115], v3, s[48:51], s55 offen offset:0 nt
  buffer_load_dwordx4 a[116:119], v3, s[48:51], s55 offen offset:1024 nt
  buffer_load_dwordx4 a[120:123], v3, s[48:51], s55 offen offset:2048 nt
  buffer_load_dwordx4 a[124:127], v3, s[48:51], s55 offen offset:3072 nt
  s_waitcnt vmcnt(20)
  v_mfma_f32_16x16x32_bf16 v[34:37], a[32:35], v[4:7], 0
  v_mfma_f32_16x16x32_bf16 v[34:37], a[36:39], v[8:11], v[34:37]
  v_mfma_f32_16x16x32_bf16 v[34:37], a[40:43], v[12:15], v[34:37]
  v_mfma_f32_16x16x32_bf16 v[34:37], a[44:47], v[16:19], v[34:37]
  s_nop 7
  v_cvt_pk_bf16_f32 v46, v34, v35
  v_cvt_pk_bf16_f32 v47, v36, v37
  v_lshlrev_b32 v48, 16, v46
  v_and_b32 v49, 0xffff0000, v46
  v_lshlrev_b32 v50, 16, v47
  v_and_b32 v51, 0xffff0000, v47
  v_mul_f32 v48, s99, v48
  v_mul_f32 v49, s99, v49
  v_mul_f32 v50, s99, v50
  v_mul_f32 v51, s99, v51
  v_cvt_pk_bf16_f32 v46, v48, v49
  v_cvt_pk_bf16_f32 v47, v50, v51
  v_lshlrev_b32 v48, 16, v46
  v_and_b32 v49, 0xffff0000, v46
  v_lshlrev_b32 v50, 16, v47
  v_and_b32 v51, 0xffff0000, v47
  v_fma_f32 v48, v48, s98, v28
  v_fma_f32 v49, v49, s98, v28
  v_fma_f32 v50, v50, s98, v28
  v_fma_f32 v51, v51, s98, v28
  v_max3_f32 v52, v48, v49, v50
  v_max_f32 v52, v52, v51
  v_cmp_lt_f32 vcc, s86, v52
  s_cbranch_vccz L_back9
  s_call_b64 s[92:93], L_rare
L_back9:
  v_exp_f32 v48, v48
  v_exp_f32 v49, v49
  v_exp_f32 v50, v50
  v_exp_f32 v51, v51
  s_nop 0
  v_cvt_pk_bf16_f32 v46, v48, v49
  v_cvt_pk_bf16_f32 v47, v50, v51
  v_add_f32 v48, v48, v49
  v_add_f32 v50, v50, v51
  v_perm_b32 v38, v46, v46, v30
  v_perm_b32 v39, v46, v46, v31
  v_perm_b32 v40, v46, v46, v32
  v_perm_b32 v41, v46, v46, v33
  v_perm_b32 v42, v47, v47, v30
  v_perm_b32 v43, v47, v47, v31
  v_perm_b32 v44, v47, v47, v32
  v_perm_b32 v45, v47, v47, v33
  v_add_f32 v48, v48, v50
  v_add_f32 v29, v29, v48
  s_waitcnt vmcnt(16)
  v_mfma_f32_16x16x16_bf16 v[20:23], v[38:39], a[48:49], v[20:23]
  v_mfma_f32_16x16x16_bf16 v[24:27], v[38:39], a[50:51], v[24:27]
  v_mfma_f32_16x16x16_bf16 v[20:23], v[40:41], a[52:53], v[20:23]
  v_mfma_f32_16x16x16_bf16 v[24:27], v[40:41], a[54:55], v[24:27]
  v_mfma_f32_16x16x16_bf16 v[20:23], v[42:43], a[56:57], v[20:23]
  v_mfma_f32_16x16x16_bf16 v[24:27], v[42:43], a[58:59], v[24:27]
  v_mfma_f32_16x16x16_bf16 v[20:23], v[44:45], a[60:61], v[20:23]
  v_mfma_f32_16x16x16_bf16 v[24:27], v[44:45], a[62:63], v[24:27]
L_loop:
  s_cmp_ge_u32 s54, 0x1000000
  s_cbranch_scc1 L_done
  s_waitcnt vmcnt(12)
  v_mfma_f32_16x16x32_bf16 v[34:37], a[64:67], v[4:7], 0
  v_mfma_f32_16x16x32_bf16 v[34:37], a[68:71], v[8:11], v[34:37]
  v_mfma_f32_16x16x32_bf16 v[34:37], a[72:75], v[12:15], v[34:37]
  v_mfma_f32_16x16x32_bf16 v[34:37], a[76:79], v[16:19], v[34:37]
  s_cmp_lt_u32 s77, 39
  s_cbranch_scc1 L_st4
  s_waitcnt lgkmcnt(1)
  s_cmp_lg_u32 s56, 1
  s_cbranch_scc1 L_tk4
  s_waitcnt lgkmcnt(0)
L_tk4:
  s_and_b32 s83, s56, 1
  s_lshl_b32 s83, s83, 21
  s_and_b32 s78, s56, 0xfffe
  s_lshl_b32 s78, s78, 11
  s_add_u32 s78, s78, s83
  s_add_u32 s78, s78, s60
  s_cmp_ge_u32 s56, 65624
  s_cselect_b32 s79, 0x1000000, s79
  s_max_u32 s78, s78, s79
L_st4:
  s_mov_b32 s52, s78
  s_add_u32 s78, s78, 49152
  s_add_u32 s77, s77, 1
  s_cmp_lg_u32 s79, 0
  s_cbranch_scc1 L_nq4
  s_cmp_lt_u32 s77, 38
  s_cbranch_scc1 L_nq4
  s_mov_b32 s58, 1
  s_atomic_add s58, s[40:41], s80 glc
L_nq4:
  buffer_load_dwordx4 a[0:3], v2, s[44:47], s52 offen offset:0 nt
  buffer_load_dwordx4 a[4:7], v2, s[44:47], s52 offen offset:64 nt
  buffer_load_dwordx4 a[8:11], v2, s[44:47], s52 offen offset:128 nt
  buffer_load_dwordx4 a[12:15], v2, s[44:47], s52 offen offset:192 nt
  buffer_load_dwordx4 a[16:19], v3, s[48:51], s52 offen offset:0 nt
  buffer_load_dwordx4 a[20:23], v3, s[48:51], s52 offen offset:1024 nt
  buffer_load_dwordx4 a[24:27], v3, s[48:51], s52 offen offset:2048 nt
  buffer_load_dwordx4 a[28:31], v3, s[48:51], s52 offen offset:3072 nt
  v_cvt_pk_bf16_f32 v46, v34, v35
  v_cvt_pk_bf16_f32 v47, v36, v37
  v_lshlrev_b32 v48, 16, v46
  v_and_b32 v49, 0xffff0000, v46
  v_lshlrev_b32 v50, 16, v47
  v_and_b32 v51, 0xffff0000, v47
  v_mul_f32 v48, s99, v48
  v_mul_f32 v49, s99, v49
  v_mul_f32 v50, s99, v50
  v_mul_f32 v51, s99, v51
  v_cvt_pk_bf16_f32 v46, v48, v49
  v_cvt_pk_bf16_f32 v47, v50, v51
  v_lshlrev_b32 v48, 16, v46
  v_and_b32 v49, 0xffff0000, v46
  v_lshlrev_b32 v50, 16, v47
  v_and_b32 v51, 0xffff0000, v47
  v_fma_f32 v48, v48, s98, v28
  v_fma_f32 v49, v49, s98, v28
  v_fma_f32 v50, v50, s98, v28
  v_fma_f32 v51, v51, s98, v28
  v_max3_f32 v52, v48, v49, v50
  v_max_f32 v52, v52, v51
  v_cmp_lt_f32 vcc, s86, v52
  s_cbranch_vccz L_back10
  s_call_b64 s[92:93], L_rare
L_back10:
  v_exp_f32 v48, v48
  v_exp_f32 v49, v49
  v_exp_f32 v50, v50
  v_exp_f32 v51, v51
  s_nop 0
  v_cvt_pk_bf16_f32 v46, v48, v49
  v_cvt_pk_bf16_f32 v47, v50, v51
  v_add_f32 v48, v48, v49
  v_add_f32 v50, v50, v51
  v_perm_b32 v38, v46, v46, v30
  v_perm_b32 v39, v46, v46, v31
  v_perm_b32 v40, v46, v46, v32
  v_perm_b32 v41, v46, v46, v33
  v_perm_b32 v42, v47, v47, v30
  v_perm_b32 v43, v47, v47, v31
  v_perm_b32 v44, v47, v47, v32
  v_perm_b32 v45, v47, v47, v33
  v_add_f32 v48, v48, v50
  v_add_f32 v29, v29, v48
  s_waitcnt vmcnt(16)
  v_mfma_f32_16x16x16_bf16 v[20:23], v[38:39], a[80:81], v[20:23]
  v_mfma_f32_16x16x16_bf16 v[24:27], v[38:39], a[82:83], v[24:27]
  v_mfma_f32_16x16x16_bf16 v[20:23], v[40:41], a[84:85], v[20:23]
  v_mfma_f32_16x16x16_bf16 v[24:27], v[40:41], a[86:87], v[24:27]
  v_mfma_f32_16x16x16_bf16 v[20:23], v[42:43], a[88:89], v[20:23]
  v_mfma_f32_16x16x16_bf16 v[24:27], v[42:43], a[90:91], v[24:27]
  v_mfma_f32_16x16x16_bf16 v[20:23], v[44:45], a[92:93], v[20:23]
  v_mfma_f32_16x16x16_bf16 v[24:27], v[44:45], a[94:95], v[24:27]
  s_cmp_ge_u32 s55, 0x1000000
  s_cbranch_scc1 L_done
  s_waitcnt vmcnt(12)
  v_mfma_f32_16x16x32_bf16 v[34:37], a[96:99], v[4:7], 0
  v_mfma_f32_16x16x32_bf16 v[34:37], a[100:103], v[8:11], v[34:37]
  v_mfma_f32_16x16x32_bf16 v[34:37], a[104:107], v[12:15], v[34:37]
  v_mfma_f32_16x16x32_bf16 v[34:37], a[108:111], v[16:19], v[34:37]
  s_cmp_lt_u32 s77, 39
  s_cbranch_scc1 L_st5
  s_waitcnt lgkmcnt(1)
  s_cmp_lg_u32 s57, 1
  s_cbranch_scc1 L_tk5
  s_waitcnt lgkmcnt(0)
L_tk5:
  s_and_b32 s83, s57, 1
  s_lshl_b32 s83, s83, 21
  s_and_b32 s78, s57, 0xfffe
  s_lshl_b32 s78, s78, 11
  s_add_u32 s78, s78, s83
  s_add_u32 s78, s78, s60
  s_cmp_ge_u32 s57, 65624
  s_cselect_b32 s79, 0x1000000, s79
  s_max_u32 s78, s78, s79
L_st5:
  s_mov_b32 s53, s78
  s_add_u32 s78, s78, 49152
  s_add_u32 s77, s77, 1
  s_cmp_lg_u32 s79, 0
  s_cbranch_scc1 L_nq5
  s_cmp_lt_u32 s77, 38
  s_cbranch_scc1 L_nq5
  s_mov_b32 s59, 1
  s_atomic_add s59, s[40:41], s80 glc
L_nq5:
  buffer_load_dwordx4 a[32:35], v2, s[44:47], s53 offen offset:0 nt
  buffer_load_dwordx4 a[36:39], v2, s[44:47], s53 offen offset:64 nt
  buffer_load_dwordx4 a[40:43], v2, s[44:47], s53 offen offset:128 nt
  buffer_load_dwordx4 a[44:47], v2, s[44:47], s53 offen offset:192 nt
  buffer_load_dwordx4 a[48:51], v3, s[48:51], s53 offen offset:0 nt
  buffer_load_dwordx4 a[52:55], v3, s[48:51], s53 offen offset:1024 nt
  buffer_load_dwordx4 a[56:59], v3, s[48:51], s53 offen offset:2048 nt
  buffer_load_dwordx4 a[60:63], v3, s[48:51], s53 offen offset:3072 nt
  v_cvt_pk_bf16_f32 v46, v34, v35
  v_cvt_pk_bf16_f32 v47, v36, v37
  v_lshlrev_b32 v48, 16, v46
  v_and_b32 v49, 0xffff0000, v46
  v_lshlrev_b32 v50, 16, v47
  v_and_b32 v51, 0xffff0000, v47
  v_mul_f32 v48, s99, v48
  v_mul_f32 v49, s99, v49
  v_mul_f32 v50, s99, v50
  v_mul_f32 v51, s99, v51
  v_cvt_pk_bf16_f32 v46, v48, v49
  v_cvt_pk_bf16_f32 v47, v50, v51
  v_lshlrev_b32 v48, 16, v46
  v_and_b32 v49, 0xffff0000, v46
  v_lshlrev_b32 v50, 16, v47
  v_and_b32 v51, 0xffff0000, v47
  v_fma_f32 v48, v48, s98, v28
  v_fma_f32 v49, v49, s98, v28
  v_fma_f32 v50, v50, s98, v28
  v_fma_f32 v51, v51, s98, v28
  v_max3_f32 v52, v48, v49, v50
  v_max_f32 v52, v52, v51
  v_cmp_lt_f32 vcc, s86, v52
  s_cbranch_vccz L_back11
  s_call_b64 s[92:93], L_rare
L_back11:
  v_exp_f32 v48, v48
  v_exp_f32 v49, v49
  v_exp_f32 v50, v50
  v_exp_f32 v51, v51
  s_nop 0
  v_cvt_pk_bf16_f32 v46, v48, v49
  v_cvt_pk_bf16_f32 v47, v50, v51
  v_add_f32 v48, v48, v49
  v_add_f32 v50, v50, v51
  v_perm_b32 v38, v46, v46, v30
  v_perm_b32 v39, v46, v46, v31
  v_perm_b32 v40, v46, v46, v32
  v_perm_b32 v41, v46, v46, v33
  v_perm_b32 v42, v47, v47, v30
  v_perm_b32 v43, v47, v47, v31
  v_perm_b32 v44, v47, v47, v32
  v_perm_b32 v45, v47, v47, v33
  v_add_f32 v48, v48, v50
  v_add_f32 v29, v29, v48
  s_waitcnt vmcnt(16)
  v_mfma_f32_16x16x16_bf16 v[20:23], v[38:39], a[112:113], v[20:23]
  v_mfma_f32_16x16x16_bf16 v[24:27], v[38:39], a[114:115], v[24:27]
  v_mfma_f32_16x16x16_bf16 v[20:23], v[40:41], a[116:117], v[20:23]
  v_mfma_f32_16x16x16_bf16 v[24:27], v[40:41], a[118:119], v[24:27]
  v_mfma_f32_16x16x16_bf16 v[20:23], v[42:43], a[120:121], v[20:23]
  v_mfma_f32_16x16x16_bf16 v[24:27], v[42:43], a[122:123], v[24:27]
  v_mfma_f32_16x16x16_bf16 v[20:23], v[44:45], a[124:125], v[20:23]
  v_mfma_f32_16x16x16_bf16 v[24:27], v[44:45], a[126:127], v[24:27]
  s_cmp_ge_u32 s52, 0x1000000
  s_cbranch_scc1 L_done
  s_waitcnt vmcnt(12)
  v_mfma_f32_16x16x32_bf16 v[34:37], a[0:3], v[4:7], 0
  v_mfma_f32_16x16x32_bf16 v[34:37], a[4:7], v[8:11], v[34:37]
  v_mfma_f32_16x16x32_bf16 v[34:37], a[8:11], v[12:15], v[34:37]
  v_mfma_f32_16x16x32_bf16 v[34:37], a[12:15], v[16:19], v[34:37]
  s_cmp_lt_u32 s77, 39
  s_cbranch_scc1 L_st6
  s_waitcnt lgkmcnt(1)
  s_cmp_lg_u32 s58, 1
  s_cbranch_scc1 L_tk6
  s_waitcnt lgkmcnt(0)
L_tk6:
  s_and_b32 s83, s58, 1
  s_lshl_b32 s83, s83, 21
  s_and_b32 s78, s58, 0xfffe
  s_lshl_b32 s78, s78, 11
  s_add_u32 s78, s78, s83
  s_add_u32 s78, s78, s60
  s_cmp_ge_u32 s58, 65624
  s_cselect_b32 s79, 0x1000000, s79
  s_max_u32 s78, s78, s79
L_st6:
  s_mov_b32 s54, s78
  s_add_u32 s78, s78, 49152
  s_add_u32 s77, s77, 1
  s_cmp_lg_u32 s79, 0
  s_cbranch_scc1 L_nq6
  s_cmp_lt_u32 s77, 38
  s_cbranch_scc1 L_nq6
  s_mov_b32 s56, 1
  s_atomic_add s56, s[40:41], s80 glc
L_nq6:
  buffer_load_dwordx4 a[64:67], v2, s[44:47], s54 offen offset:0 nt
  buffer_load_dwordx4 a[68:71], v2, s[44:47], s54 offen offset:64 nt
  buffer_load_dwordx4 a[72:75], v2, s[44:47], s54 offen offset:128 nt
  buffer_load_dwordx4 a[76:79], v2, s[44:47], s54 offen offset:192 nt
  buffer_load_dwordx4 a[80:83], v3, s[48:51], s54 offen offset:0 nt
  buffer_load_dwordx4 a[84:87], v3, s[48:51], s54 offen offset:1024 nt
  buffer_load_dwordx4 a[88:91], v3, s[48:51], s54 offen offset:2048 nt
  buffer_load_dwordx4 a[92:95], v3, s[48:51], s54 offen offset:3072 nt
  v_cvt_pk_bf16_f32 v46, v34, v35
  v_cvt_pk_bf16_f32 v47, v36, v37
  v_lshlrev_b32 v48, 16, v46
  v_and_b32 v49, 0xffff0000, v46
  v_lshlrev_b32 v50, 16, v47
  v_and_b32 v51, 0xffff0000, v47
  v_mul_f32 v48, s99, v48
  v_mul_f32 v49, s99, v49
  v_mul_f32 v50, s99, v50
  v_mul_f32 v51, s99, v51
  v_cvt_pk_bf16_f32 v46, v48, v49
  v_cvt_pk_bf16_f32 v47, v50, v51
  v_lshlrev_b32 v48, 16, v46
  v_and_b32 v49, 0xffff0000, v46
  v_lshlrev_b32 v50, 16, v47
  v_and_b32 v51, 0xffff0000, v47
  v_fma_f32 v48, v48, s98, v28
  v_fma_f32 v49, v49, s98, v28
  v_fma_f32 v50, v50, s98, v28
  v_fma_f32 v51, v51, s98, v28
  v_max3_f32 v52, v48, v49, v50
  v_max_f32 v52, v52, v51
  v_cmp_lt_f32 vcc, s86, v52
  s_cbranch_vccz L_back12
  s_call_b64 s[92:93], L_rare
L_back12:
  v_exp_f32 v48, v48
  v_exp_f32 v49, v49
  v_exp_f32 v50, v50
  v_exp_f32 v51, v51
  s_nop 0
  v_cvt_pk_bf16_f32 v46, v48, v49
  v_cvt_pk_bf16_f32 v47, v50, v51
  v_add_f32 v48, v48, v49
  v_add_f32 v50, v50, v51
  v_perm_b32 v38, v46, v46, v30
  v_perm_b32 v39, v46, v46, v31
  v_perm_b32 v40, v46, v46, v32
  v_perm_b32 v41, v46, v46, v33
  v_perm_b32 v42, v47, v47, v30
  v_perm_b32 v43, v47, v47, v31
  v_perm_b32 v44, v47, v47, v32
  v_perm_b32 v45, v47, v47, v33
  v_add_f32 v48, v48, v50
  v_add_f32 v29, v29, v48
  s_waitcnt vmcnt(16)
  v_mfma_f32_16x16x16_bf16 v[20:23], v[38:39], a[16:17], v[20:23]
  v_mfma_f32_16x16x16_bf16 v[24:27], v[38:39], a[18:19], v[24:27]
  v_mfma_f32_16x16x16_bf16 v[20:23], v[40:41], a[20:21], v[20:23]
  v_mfma_f32_16x16x16_bf16 v[24:27], v[40:41], a[22:23], v[24:27]
  v_mfma_f32_16x16x16_bf16 v[20:23], v[42:43], a[24:25], v[20:23]
  v_mfma_f32_16x16x16_bf16 v[24:27], v[42:43], a[26:27], v[24:27]
  v_mfma_f32_16x16x16_bf16 v[20:23], v[44:45], a[28:29], v[20:23]
  v_mfma_f32_16x16x16_bf16 v[24:27], v[44:45], a[30:31], v[24:27]
  s_cmp_ge_u32 s53, 0x1000000
  s_cbranch_scc1 L_done
  s_waitcnt vmcnt(12)
  v_mfma_f32_16x16x32_bf16 v[34:37], a[32:35], v[4:7], 0
  v_mfma_f32_16x16x32_bf16 v[34:37], a[36:39], v[8:11], v[34:37]
  v_mfma_f32_16x16x32_bf16 v[34:37], a[40:43], v[12:15], v[34:37]
  v_mfma_f32_16x16x32_bf16 v[34:37], a[44:47], v[16:19], v[34:37]
  s_cmp_lt_u32 s77, 39
  s_cbranch_scc1 L_st7
  s_waitcnt lgkmcnt(1)
  s_cmp_lg_u32 s59, 1
  s_cbranch_scc1 L_tk7
  s_waitcnt lgkmcnt(0)
L_tk7:
  s_and_b32 s83, s59, 1
  s_lshl_b32 s83, s83, 21
  s_and_b32 s78, s59, 0xfffe
  s_lshl_b32 s78, s78, 11
  s_add_u32 s78, s78, s83
  s_add_u32 s78, s78, s60
  s_cmp_ge_u32 s59, 65624
  s_cselect_b32 s79, 0x1000000, s79
  s_max_u32 s78, s78, s79
L_st7:
  s_mov_b32 s55, s78
  s_add_u32 s78, s78, 49152
  s_add_u32 s77, s77, 1
  s_cmp_lg_u32 s79, 0
  s_cbranch_scc1 L_nq7
  s_cmp_lt_u32 s77, 38
  s_cbranch_scc1 L_nq7
  s_mov_b32 s57, 1
  s_atomic_add s57, s[40:41], s80 glc
L_nq7:
  buffer_load_dwordx4 a[96:99], v2, s[44:47], s55 offen offset:0 nt
  buffer_load_dwordx4 a[100:103], v2, s[44:47], s55 offen offset:64 nt
  buffer_load_dwordx4 a[104:107], v2, s[44:47], s55 offen offset:128 nt
  buffer_load_dwordx4 a[108:111], v2, s[44:47], s55 offen offset:192 nt
  buffer_load_dwordx4 a[112:115], v3, s[48:51], s55 offen offset:0 nt
  buffer_load_dwordx4 a[116:119], v3, s[48:51], s55 offen offset:1024 nt
  buffer_load_dwordx4 a[120:123], v3, s[48:51], s55 offen offset:2048 nt
  buffer_load_dwordx4 a[124:127], v3, s[48:51], s55 offen offset:3072 nt
  v_cvt_pk_bf16_f32 v46, v34, v35
  v_cvt_pk_bf16_f32 v47, v36, v37
  v_lshlrev_b32 v48, 16, v46
  v_and_b32 v49, 0xffff0000, v46
  v_lshlrev_b32 v50, 16, v47
  v_and_b32 v51, 0xffff0000, v47
  v_mul_f32 v48, s99, v48
  v_mul_f32 v49, s99, v49
  v_mul_f32 v50, s99, v50
  v_mul_f32 v51, s99, v51
  v_cvt_pk_bf16_f32 v46, v48, v49
  v_cvt_pk_bf16_f32 v47, v50, v51
  v_lshlrev_b32 v48, 16, v46
  v_and_b32 v49, 0xffff0000, v46
  v_lshlrev_b32 v50, 16, v47
  v_and_b32 v51, 0xffff0000, v47
  v_fma_f32 v48, v48, s98, v28
  v_fma_f32 v49, v49, s98, v28
  v_fma_f32 v50, v50, s98, v28
  v_fma_f32 v51, v51, s98, v28
  v_max3_f32 v52, v48, v49, v50
  v_max_f32 v52, v52, v51
  v_cmp_lt_f32 vcc, s86, v52
  s_cbranch_vccz L_back13
  s_call_b64 s[92:93], L_rare
L_back13:
  v_exp_f32 v48, v48
  v_exp_f32 v49, v49
  v_exp_f32 v50, v50
  v_exp_f32 v51, v51
  s_nop 0
  v_cvt_pk_bf16_f32 v46, v48, v49
  v_cvt_pk_bf16_f32 v47, v50, v51
  v_add_f32 v48, v48, v49
  v_add_f32 v50, v50, v51
  v_perm_b32 v38, v46, v46, v30
  v_perm_b32 v39, v46, v46, v31
  v_perm_b32 v40, v46, v46, v32
  v_perm_b32 v41, v46, v46, v33
  v_perm_b32 v42, v47, v47, v30
  v_perm_b32 v43, v47, v47, v31
  v_perm_b32 v44, v47, v47, v32
  v_perm_b32 v45, v47, v47, v33
  v_add_f32 v48, v48, v50
  v_add_f32 v29, v29, v48
  s_waitcnt vmcnt(16)
  v_mfma_f32_16x16x16_bf16 v[20:23], v[38:39], a[48:49], v[20:23]
  v_mfma_f32_16x16x16_bf16 v[24:27], v[38:39], a[50:51], v[24:27]
  v_mfma_f32_16x16x16_bf16 v[20:23], v[40:41], a[52:53], v[20:23]
  v_mfma_f32_16x16x16_bf16 v[24:27], v[40:41], a[54:55], v[24:27]
  v_mfma_f32_16x16x16_bf16 v[20:23], v[42:43], a[56:57], v[20:23]
  v_mfma_f32_16x16x16_bf16 v[24:27], v[42:43], a[58:59], v[24:27]
  v_mfma_f32_16x16x16_bf16 v[20:23], v[44:45], a[60:61], v[20:23]
  v_mfma_f32_16x16x16_bf16 v[24:27], v[44:45], a[62:63], v[24:27]
  s_branch L_loop
L_rare:
  v_mov_b32 v53, v52
  s_nop 1
  v_permlane16_swap_b32 v52, v53
  s_nop 0
  v_max_f32 v52, v52, v53
  v_mov_b32 v53, v52
  s_nop 1
  v_permlane32_swap_b32 v52, v53
  s_nop 0
  v_max_f32 v52, v52, v53
  v_max_f32 v52, s87, v52
  v_sub_f32 v48, v48, v52
  v_sub_f32 v49, v49, v52
  v_sub_f32 v50, v50, v52
  v_sub_f32 v51, v51, v52
  v_sub_f32 v28, v28, v52
  v_max_f32 v53, 0, v52
  v_exp_f32 v53, -v53
  s_nop 0
  v_mul_f32 v29, v29, v53
  s_nop 0
  v_mov_b32_dpp v54, v53 row_newbcast:0 row_mask:0x1 bank_mask:0xf
  v_mov_b32_dpp v54, v53 row_newbcast:4 row_mask:0x2 bank_mask:0xf
  v_mov_b32_dpp v54, v53 row_newbcast:8 row_mask:0x4 bank_mask:0xf
  v_mov_b32_dpp v54, v53 row_newbcast:12 row_mask:0x8 bank_mask:0xf
  v_mul_f32 v20, v20, v54
  v_mul_f32 v21, v21, v54
  v_mul_f32 v22, v22, v54
  v_mul_f32 v23, v23, v54
  v_mul_f32 v24, v24, v54
  v_mul_f32 v25, v25, v54
  v_mul_f32 v26, v26, v54
  v_mul_f32 v27, v27, v54
  s_mov_b32 s86, 0x41a00000
  s_mov_b32 s87, 0
  s_setpc_b64 s[92:93]
L_done:
  v_mov_b32 v46, v29
  s_nop 1
  v_permlane16_swap_b32 v29, v46
  s_nop 0
  v_add_f32 v29, v29, v46
  v_mov_b32 v46, v29
  s_nop 1
  v_permlane32_swap_b32 v29, v46
  s_nop 0
  v_add_f32 v29, v29, v46
  ds_write_b128 v81, v[20:23] offset:2304
  ds_write_b128 v81, v[24:27] offset:2320
  ds_write_b64 v82, v[28:29] offset:2048
  v_cmp_ne_u32 vcc, 0, v86
  s_waitcnt lgkmcnt(0)
  s_barrier
  ds_read_b64 v[6:7], v83 offset:2056
  ds_read_b128 v[8:11], v83 offset:2064
  ds_read_b64 v[52:53], v84 offset:4352
  ds_read_b64 v[54:55], v84 offset:6400
  ds_read_b64 v[56:57], v84 offset:8448
  v_mov_b32 v19, s43
  s_waitcnt lgkmcnt(3)
  v_min3_f32 v12, v6, v8, v10
  v_sub_f32 v6, v12, v6
  v_sub_f32 v8, v12, v8
  v_sub_f32 v10, v12, v10
  v_exp_f32 v6, v6
  v_exp_f32 v8, v8
  v_exp_f32 v10, v10
  s_nop 0
  v_mul_f32 v13, v6, v7
  v_fmac_f32 v13, v8, v9
  v_fmac_f32 v13, v10, v11
  v_cndmask_b32 v12, v12, v13, vcc
  v_bfe_u32 v12, v12, v85, 16
  v_or_b32 v18, s61, v12
  s_waitcnt lgkmcnt(0)
  v_mul_f32 v16, v6, v52
  v_mul_f32 v17, v6, v53
  v_fmac_f32 v16, v8, v54
  v_fmac_f32 v17, v8, v55
  v_fmac_f32 v16, v10, v56
  v_fmac_f32 v17, v10, v57
  global_store_dwordx4 v80, v[16:19], s[40:41] sc1
  s_mov_b32 s82, 0x05040100
  s_mov_b32 s85, 0
  s_waitcnt vmcnt(0)
L_pollBw:
  global_load_dwordx4 v[104:107], v88, s[40:41] offset:0 sc1
  global_load_dwordx4 v[108:111], v88, s[40:41] offset:1024 sc1
  global_load_dwordx4 v[112:115], v88, s[40:41] offset:2048 sc1
  global_load_dwordx4 v[116:119], v88, s[40:41] offset:3072 sc1
  s_waitcnt vmcnt(0)
  v_xor_b32 v46, s61, v106
  v_xor_b32 v47, s61, v110
  v_xor_b32 v48, s61, v114
  v_xor_b32 v49, s61, v118
  v_or3_b32 v46, v46, v47, v48
  v_or_b32 v46, v46, v49
  v_lshrrev_b32 v46, 16, v46
  v_xor_b32 v47, s43, v107
  v_xor_b32 v48, s43, v111
  v_or3_b32 v46, v46, v47, v48
  v_xor_b32 v47, s43, v115
  v_xor_b32 v48, s43, v119
  v_or3_b32 v46, v46, v47, v48
  v_cmp_ne_u32 vcc, 0, v46
  s_and_b64 exec, exec, vcc
  s_cbranch_execz L_pollB_donew
  s_add_u32 s85, s85, 1
  s_cmp_lt_u32 s85, 4000000
  s_cbranch_scc1 L_pollBw
L_pollB_donew:
  s_mov_b64 exec, -1
  v_mov_b32_dpp v58, v106 quad_perm:[0,0,0,0] row_mask:0xf bank_mask:0xf
  v_mov_b32_dpp v62, v106 quad_perm:[1,1,1,1] row_mask:0xf bank_mask:0xf
  v_mov_b32_dpp v59, v110 quad_perm:[0,0,0,0] row_mask:0xf bank_mask:0xf
  v_mov_b32_dpp v63, v110 quad_perm:[1,1,1,1] row_mask:0xf bank_mask:0xf
  v_mov_b32_dpp v60, v114 quad_perm:[0,0,0,0] row_mask:0xf bank_mask:0xf
  v_mov_b32_dpp v64, v114 quad_perm:[1,1,1,1] row_mask:0xf bank_mask:0xf
  v_mov_b32_dpp v61, v118 quad_perm:[0,0,0,0] row_mask:0xf bank_mask:0xf
  v_mov_b32_dpp v65, v118 quad_perm:[1,1,1,1] row_mask:0xf bank_mask:0xf
  v_perm_b32 v50, v62, v58, s82
  v_perm_b32 v51, v63, v59, s82
  v_perm_b32 v52, v64, v60, s82
  v_perm_b32 v53, v65, v61, s82
  v_min3_f32 v46, v50, v51, v52
  v_min_f32 v46, v46, v53
  v_mov_b32_dpp v58, v106 quad_perm:[2,2,2,2] row_mask:0xf bank_mask:0xf
  v_mov_b32_dpp v62, v106 quad_perm:[3,3,3,3] row_mask:0xf bank_mask:0xf
  v_min_f32_dpp v46, v46, v46 row_ror:8 row_mask:0xf bank_mask:0xf
  v_mov_b32 v47, v46
  v_mov_b32_dpp v59, v110 quad_perm:[2,2,2,2] row_mask:0xf bank_mask:0xf
  v_mov_b32_dpp v63, v110 quad_perm:[3,3,3,3] row_mask:0xf bank_mask:0xf
  v_permlane16_swap_b32 v46, v47
  v_mov_b32_dpp v60, v114 quad_perm:[2,2,2,2] row_mask:0xf bank_mask:0xf
  v_min_f32 v46, v46, v47
  v_mov_b32 v47, v46
  v_mov_b32_dpp v64, v114 quad_perm:[3,3,3,3] row_mask:0xf bank_mask:0xf
  v_mov_b32_dpp v61, v118 quad_perm:[2,2,2,2] row_mask:0xf bank_mask:0xf
  v_permlane32_swap_b32 v46, v47
  v_mov_b32_dpp v65, v118 quad_perm:[3,3,3,3] row_mask:0xf bank_mask:0xf
  v_min_f32 v46, v46, v47
  v_sub_f32 v50, v46, v50
  v_sub_f32 v51, v46, v51
  v_sub_f32 v52, v46, v52
  v_sub_f32 v53, v46, v53
  v_exp_f32 v50, v50
  v_exp_f32 v51, v51
  v_exp_f32 v52, v52
  v_exp_f32 v53, v53
  v_perm_b32 v54, v62, v58, s82
  v_perm_b32 v55, v63, v59, s82
  v_perm_b32 v56, v64, v60, s82
  v_perm_b32 v57, v65, v61, s82
  v_mul_f32 v46, v50, v104
  v_mul_f32 v47, v50, v105
  v_mul_f32 v48, v50, v54
  v_fmac_f32 v46, v51, v108
  v_fmac_f32 v47, v51, v109
  v_fmac_f32 v48, v51, v55
  v_fmac_f32 v46, v52, v112
  v_fmac_f32 v47, v52, v113
  v_fmac_f32 v48, v52, v56
  v_fmac_f32 v46, v53, v116
  v_fmac_f32 v47, v53, v117
  v_fmac_f32 v48, v53, v57
  v_mov_b32 v49, v48
  v_permlane32_swap_b32 v46, v47
  s_nop 0
  v_permlane32_swap_b32 v48, v49
  v_add_f32 v46, v46, v47
  v_add_f32 v48, v48, v49
  v_mov_b32 v47, v46
  v_mov_b32 v49, v48
  s_nop 0
  v_permlane16_swap_b32 v46, v47
  v_permlane16_swap_b32 v48, v49
  v_add_f32 v46, v46, v47
  v_add_f32 v48, v48, v49
  s_nop 0
  v_add_f32_dpp v46, v46, v46 row_ror:8 row_mask:0xf bank_mask:0xf
  v_add_f32_dpp v48, v48, v48 row_ror:8 row_mask:0xf bank_mask:0xf
  v_rcp_f32 v49, v48
  v_mov_b32_dpp v46, v46 row_shl:1 row_mask:0xa bank_mask:0xf
  v_fma_f32 v47, -v48, v49, 1.0
  v_fma_f32 v49, v47, v49, v49
  v_mul_f32 v46, v46, v49
  v_cvt_pk_bf16_f32 v46, v46, v46
  s_nop 1
  v_and_b32_dpp v4, v46, v216 row_newbcast:0 row_mask:0xf bank_mask:0xf
  v_and_b32_dpp v5, v46, v217 row_newbcast:0 row_mask:0xf bank_mask:0xf
  v_and_b32_dpp v6, v46, v218 row_newbcast:0 row_mask:0xf bank_mask:0xf
  v_and_b32_dpp v7, v46, v219 row_newbcast:0 row_mask:0xf bank_mask:0xf
  v_and_b32_dpp v8, v46, v216 row_newbcast:2 row_mask:0xf bank_mask:0xf
  v_and_b32_dpp v9, v46, v217 row_newbcast:2 row_mask:0xf bank_mask:0xf
  v_and_b32_dpp v10, v46, v218 row_newbcast:2 row_mask:0xf bank_mask:0xf
  v_and_b32_dpp v11, v46, v219 row_newbcast:2 row_mask:0xf bank_mask:0xf
  v_mfma_f32_16x16x32_bf16 v[120:123], v[4:7], v[200:203], 0
  v_and_b32_dpp v12, v46, v216 row_newbcast:4 row_mask:0xf bank_mask:0xf
  v_and_b32_dpp v13, v46, v217 row_newbcast:4 row_mask:0xf bank_mask:0xf
  v_and_b32_dpp v14, v46, v218 row_newbcast:4 row_mask:0xf bank_mask:0xf
  v_and_b32_dpp v15, v46, v219 row_newbcast:4 row_mask:0xf bank_mask:0xf
  v_mfma_f32_16x16x32_bf16 v[120:123], v[8:11], v[204:207], v[120:123]
  v_and_b32_dpp v16, v46, v216 row_newbcast:6 row_mask:0xf bank_mask:0xf
  v_and_b32_dpp v17, v46, v217 row_newbcast:6 row_mask:0xf bank_mask:0xf
  v_and_b32_dpp v18, v46, v218 row_newbcast:6 row_mask:0xf bank_mask:0xf
  v_and_b32_dpp v19, v46, v219 row_newbcast:6 row_mask:0xf bank_mask:0xf
  v_mfma_f32_16x16x32_bf16 v[120:123], v[12:15], v[208:211], v[120:123]
  s_nop 0
  v_mfma_f32_16x16x32_bf16 v[120:123], v[16:19], v[212:215], v[120:123]
  s_mov_b64 exec, 0xffffffff
  s_nop 6
  ds_write_b128 v87, v[120:123] offset:10496
  s_mov_b64 exec, -1
  s_waitcnt lgkmcnt(0)
  s_barrier
  s_branch L_fin
L_tail:
  v_cmp_ne_u32 vcc, 0, v86
  s_waitcnt lgkmcnt(0)
  s_barrier
  ds_read_b64 v[6:7], v83 offset:2056
  ds_read_b128 v[8:11], v83 offset:2064
  ds_read_b64 v[52:53], v84 offset:4352
  ds_read_b64 v[54:55], v84 offset:6400
  ds_read_b64 v[56:57], v84 offset:8448
  v_mov_b32 v19, s43
  s_waitcnt lgkmcnt(3)
  v_min3_f32 v12, v6, v8, v10
  v_sub_f32 v6, v12, v6
  v_sub_f32 v8, v12, v8
  v_sub_f32 v10, v12, v10
  v_exp_f32 v6, v6
  v_exp_f32 v8, v8
  v_exp_f32 v10, v10
  s_nop 0
  v_mul_f32 v13, v6, v7
  v_fmac_f32 v13, v8, v9
  v_fmac_f32 v13, v10, v11
  v_cndmask_b32 v12, v12, v13, vcc
  v_bfe_u32 v12, v12, v85, 16
  v_or_b32 v18, s61, v12
  s_waitcnt lgkmcnt(0)
  v_mul_f32 v16, v6, v52
  v_mul_f32 v17, v6, v53
  v_fmac_f32 v16, v8, v54
  v_fmac_f32 v17, v8, v55
  v_fmac_f32 v16, v10, v56
  v_fmac_f32 v17, v10, v57
  global_store_dwordx4 v80, v[16:19], s[40:41] sc1
  s_mov_b32 s82, 0x05040100
  s_mov_b32 s85, 0
  s_waitcnt vmcnt(0)
L_pollBs:
  global_load_dwordx4 v[104:107], v88, s[40:41] offset:0 sc1
  global_load_dwordx4 v[108:111], v88, s[40:41] offset:1024 sc1
  global_load_dwordx4 v[112:115], v88, s[40:41] offset:2048 sc1
  global_load_dwordx4 v[116:119], v88, s[40:41] offset:3072 sc1
  s_waitcnt vmcnt(0)
  v_xor_b32 v46, s61, v106
  v_xor_b32 v47, s61, v110
  v_xor_b32 v48, s61, v114
  v_xor_b32 v49, s61, v118
  v_or3_b32 v46, v46, v47, v48
  v_or_b32 v46, v46, v49
  v_lshrrev_b32 v46, 16, v46
  v_xor_b32 v47, s43, v107
  v_xor_b32 v48, s43, v111
  v_or3_b32 v46, v46, v47, v48
  v_xor_b32 v47, s43, v115
  v_xor_b32 v48, s43, v119
  v_or3_b32 v46, v46, v47, v48
  v_cmp_ne_u32 vcc, 0, v46
  s_and_b64 exec, exec, vcc
  s_cbranch_execz L_pollB_dones
  s_add_u32 s85, s85, 1
  s_cmp_lt_u32 s85, 4000000
  s_cbranch_scc1 L_pollBs
L_pollB_dones:
  s_mov_b64 exec, -1
  v_mov_b32_dpp v58, v106 quad_perm:[0,0,0,0] row_mask:0xf bank_mask:0xf
  v_mov_b32_dpp v62, v106 quad_perm:[1,1,1,1] row_mask:0xf bank_mask:0xf
  v_mov_b32_dpp v59, v110 quad_perm:[0,0,0,0] row_mask:0xf bank_mask:0xf
  v_mov_b32_dpp v63, v110 quad_perm:[1,1,1,1] row_mask:0xf bank_mask:0xf
  v_mov_b32_dpp v60, v114 quad_perm:[0,0,0,0] row_mask:0xf bank_mask:0xf
  v_mov_b32_dpp v64, v114 quad_perm:[1,1,1,1] row_mask:0xf bank_mask:0xf
  v_mov_b32_dpp v61, v118 quad_perm:[0,0,0,0] row_mask:0xf bank_mask:0xf
  v_mov_b32_dpp v65, v118 quad_perm:[1,1,1,1] row_mask:0xf bank_mask:0xf
  v_perm_b32 v50, v62, v58, s82
  v_perm_b32 v51, v63, v59, s82
  v_perm_b32 v52, v64, v60, s82
  v_perm_b32 v53, v65, v61, s82
  v_min3_f32 v46, v50, v51, v52
  v_min_f32 v46, v46, v53
  v_mov_b32_dpp v58, v106 quad_perm:[2,2,2,2] row_mask:0xf bank_mask:0xf
  v_mov_b32_dpp v62, v106 quad_perm:[3,3,3,3] row_mask:0xf bank_mask:0xf
  v_min_f32_dpp v46, v46, v46 row_ror:8 row_mask:0xf bank_mask:0xf
  v_mov_b32 v47, v46
  v_mov_b32_dpp v59, v110 quad_perm:[2,2,2,2] row_mask:0xf bank_mask:0xf
  v_mov_b32_dpp v63, v110 quad_perm:[3,3,3,3] row_mask:0xf bank_mask:0xf
  v_permlane16_swap_b32 v46, v47
  v_mov_b32_dpp v60, v114 quad_perm:[2,2,2,2] row_mask:0xf bank_mask:0xf
  v_min_f32 v46, v46, v47
  v_mov_b32 v47, v46
  v_mov_b32_dpp v64, v114 quad_perm:[3,3,3,3] row_mask:0xf bank_mask:0xf
  v_mov_b32_dpp v61, v118 quad_perm:[2,2,2,2] row_mask:0xf bank_mask:0xf
  v_permlane32_swap_b32 v46, v47
  v_mov_b32_dpp v65, v118 quad_perm:[3,3,3,3] row_mask:0xf bank_mask:0xf
  v_min_f32 v46, v46, v47
  v_sub_f32 v50, v46, v50
  v_sub_f32 v51, v46, v51
  v_sub_f32 v52, v46, v52
  v_sub_f32 v53, v46, v53
  v_exp_f32 v50, v50
  v_exp_f32 v51, v51
  v_exp_f32 v52, v52
  v_exp_f32 v53, v53
  v_perm_b32 v54, v62, v58, s82
  v_perm_b32 v55, v63, v59, s82
  v_perm_b32 v56, v64, v60, s82
  v_perm_b32 v57, v65, v61, s82
  v_mul_f32 v46, v50, v104
  v_mul_f32 v47, v50, v105
  v_mul_f32 v48, v50, v54
  v_fmac_f32 v46, v51, v108
  v_fmac_f32 v47, v51, v109
  v_fmac_f32 v48, v51, v55
  v_fmac_f32 v46, v52, v112
  v_fmac_f32 v47, v52, v113
  v_fmac_f32 v48, v52, v56
  v_fmac_f32 v46, v53, v116
  v_fmac_f32 v47, v53, v117
  v_fmac_f32 v48, v53, v57
  v_mov_b32 v49, v48
  v_permlane32_swap_b32 v46, v47
  s_nop 0
  v_permlane32_swap_b32 v48, v49
  v_add_f32 v46, v46, v47
  v_add_f32 v48, v48, v49
  v_mov_b32 v47, v46
  v_mov_b32 v49, v48
  s_nop 0
  v_permlane16_swap_b32 v46, v47
  v_permlane16_swap_b32 v48, v49
  v_add_f32 v46, v46, v47
  v_add_f32 v48, v48, v49
  s_nop 0
  v_add_f32_dpp v46, v46, v46 row_ror:8 row_mask:0xf bank_mask:0xf
  v_add_f32_dpp v48, v48, v48 row_ror:8 row_mask:0xf bank_mask:0xf
  v_rcp_f32 v49, v48
  v_mov_b32_dpp v46, v46 row_shl:1 row_mask:0xa bank_mask:0xf
  v_fma_f32 v47, -v48, v49, 1.0
  v_fma_f32 v49, v47, v49, v49
  v_mul_f32 v46, v46, v49
  v_cvt_pk_bf16_f32 v46, v46, v46
  s_nop 1
  v_and_b32_dpp v4, v46, v216 row_newbcast:0 row_mask:0xf bank_mask:0xf
  v_and_b32_dpp v5, v46, v217 row_newbcast:0 row_mask:0xf bank_mask:0xf
  v_and_b32_dpp v6, v46, v218 row_newbcast:0 row_mask:0xf bank_mask:0xf
  v_and_b32_dpp v7, v46, v219 row_newbcast:0 row_mask:0xf bank_mask:0xf
  v_and_b32_dpp v8, v46, v216 row_newbcast:2 row_mask:0xf bank_mask:0xf
  v_and_b32_dpp v9, v46, v217 row_newbcast:2 row_mask:0xf bank_mask:0xf
  v_and_b32_dpp v10, v46, v218 row_newbcast:2 row_mask:0xf bank_mask:0xf
  v_and_b32_dpp v11, v46, v219 row_newbcast:2 row_mask:0xf bank_mask:0xf
  v_mfma_f32_16x16x32_bf16 v[120:123], v[4:7], v[200:203], 0
  v_and_b32_dpp v12, v46, v216 row_newbcast:4 row_mask:0xf bank_mask:0xf
  v_and_b32_dpp v13, v46, v217 row_newbcast:4 row_mask:0xf bank_mask:0xf
  v_and_b32_dpp v14, v46, v218 row_newbcast:4 row_mask:0xf bank_mask:0xf
  v_and_b32_dpp v15, v46, v219 row_newbcast:4 row_mask:0xf bank_mask:0xf
  v_mfma_f32_16x16x32_bf16 v[120:123], v[8:11], v[204:207], v[120:123]
  v_and_b32_dpp v16, v46, v216 row_newbcast:6 row_mask:0xf bank_mask:0xf
  v_and_b32_dpp v17, v46, v217 row_newbcast:6 row_mask:0xf bank_mask:0xf
  v_and_b32_dpp v18, v46, v218 row_newbcast:6 row_mask:0xf bank_mask:0xf
  v_and_b32_dpp v19, v46, v219 row_newbcast:6 row_mask:0xf bank_mask:0xf
  v_mfma_f32_16x16x32_bf16 v[120:123], v[12:15], v[208:211], v[120:123]
  s_nop 0
  v_mfma_f32_16x16x32_bf16 v[120:123], v[16:19], v[212:215], v[120:123]
  s_mov_b64 exec, 0xffffffff
  s_nop 6
  ds_write_b128 v87, v[120:123] offset:10496
  s_mov_b64 exec, -1
  s_waitcnt lgkmcnt(0)
  s_barrier
  ds_read_b64 v[108:109], v97 offset:10496
  ds_read_b64 v[110:111], v97 offset:11008
  ds_read_b64 v[112:113], v97 offset:11520
  ds_read_b64 v[114:115], v97 offset:12032
  v_mov_b32 v106, s42
  v_mov_b32 v107, s43
  s_waitcnt lgkmcnt(0)
  v_add_f32 v108, v108, v110
  v_add_f32 v109, v109, v111
  v_add_f32 v112, v112, v114
  v_add_f32 v113, v113, v115
  v_add_f32 v104, v108, v112
  v_add_f32 v105, v109, v113
  global_store_dwordx4 v89, v[104:107], s[40:41] sc1
  s_mov_b32 s85, 0
  s_waitcnt vmcnt(0)
L_pollC:
  global_load_dwordx4 v[108:111], v96, s[40:41] sc1
  s_waitcnt vmcnt(0)
  v_xor_b32 v46, s42, v110
  v_xor_b32 v47, s43, v111
  v_or_b32 v46, v46, v47
  v_cmp_ne_u32 vcc, 0, v46
  s_and_b64 exec, exec, vcc
  s_cbranch_execz L_pollC_done
  s_add_u32 s85, s85, 1
  s_cmp_lt_u32 s85, 4000000
  s_cbranch_scc1 L_pollC
L_pollC_done:
  s_mov_b64 exec, -1
  s_nop 1
  v_permlane32_swap_b32 v108, v109
  s_nop 0
  v_add_f32 v108, v108, v109
  s_nop 1
  v_add_f32_dpp v108, v108, v108 quad_perm:[1,0,3,2] row_mask:0xf bank_mask:0xf
  s_nop 1
  v_add_f32_dpp v108, v108, v108 quad_perm:[2,3,0,1] row_mask:0xf bank_mask:0xf
  s_nop 1
  v_add_f32_dpp v108, v108, v108 row_half_mirror row_mask:0xf bank_mask:0xf
  s_nop 1
  v_add_f32_dpp v108, v108, v108 row_mirror row_mask:0xf bank_mask:0xf
  v_mov_b32 v46, v108
  s_nop 1
  v_permlane16_swap_b32 v108, v46
  s_nop 0
  v_add_f32 v108, v108, v46
  v_mov_b32 v109, v108
  s_nop 1
  v_permlane32_swap_b32 v108, v109
  s_nop 0
  v_cvt_pk_bf16_f32 v109, v108, v109
  v_lshlrev_b32 v108, 16, v109
  v_and_b32 v109, 0xffff0000, v109
  v_mul_f32 v108, v108, v232
  v_mul_f32 v109, v109, v233
  v_cvt_pk_bf16_f32 v109, v108, v109
  v_lshlrev_b32 v108, 16, v109
  v_and_b32 v109, 0xffff0000, v109
  v_add_f32 v108, v108, v91
  v_add_f32 v109, v109, v92
  v_cvt_pk_bf16_f32 v108, v108, v109
  s_mov_b64 exec, 1
  global_store_dword v90, v108, s[36:37]
  s_cmp_lg_u32 s2, 0
  s_cbranch_scc1 L_noep
  v_mov_b32 v46, 32768
  v_mov_b32 v47, 3145728
  v_mov_b32 v48, s42
  v_mov_b32 v49, s43
  global_store_dword v46, v48, s[40:41] sc1
  global_store_dword v47, v49, s[40:41] sc1
L_noep:
  s_mov_b64 exec, -1
L_fin:
L_end:
  s_endpgm
.section .rodata,"a"
.p2align 6
.amdhsa_kernel recurrent_scan__gqa_block_cached__mixer_token_mlp__decode_kernel
  .amdhsa_next_free_vgpr 492
  .amdhsa_next_free_sgpr 102
  .amdhsa_accum_offset 236
  .amdhsa_group_segment_fixed_size 0
  .amdhsa_kernarg_size 104
  .amdhsa_user_sgpr_count 2
  .amdhsa_user_sgpr_kernarg_segment_ptr 1
  .amdhsa_system_sgpr_workgroup_id_x 1
  .amdhsa_float_denorm_mode_32 3
.end_amdhsa_kernel
```
